```python
import torch

def _softmax(x, axis=-1):
    return torch.softmax(x, dim=axis)
def _gelu(x):
    return torch.nn.functional.gelu(x, approximate="tanh")
def _silu(x):
    return torch.nn.functional.silu(x)
def _sigmoid(x):
    return torch.sigmoid(x)
def _layernorm(x, axis=-1, eps=1e-5):
    m = x.mean(dim=axis, keepdim=True)
    v = x.var(dim=axis, keepdim=True, unbiased=False)
    return (x - m) / torch.sqrt(v + eps)
def _scatter_add(tgt, idx, src, axis=0):
    return tgt.clone().index_add_(axis, idx, src)
def _segment_sum(src, seg, n):
    out = torch.zeros((n,) + src.shape[1:], dtype=src.dtype)
    return out.index_add_(0, seg, src)
def _pad(x, pw):
    flat = tuple(v for pair in reversed(pw) for v in pair)
    return torch.nn.functional.pad(x, flat)

kernel_name = 'recurrent_scan__ssm_conv_h3__glu_gated_geglu__prompt'

def setup_inputs():

    _w = (lambda a: (lambda t: t.to(torch.bfloat16) if t.is_floating_point() else t)(torch.as_tensor(a)))
    def _A_setup():
        B, S, D = 1, 2048, 512
        ks = 4
        return {
            "q": _w((lambda *s: torch.randn(*s, dtype=torch.bfloat16) * 0.05)(B, S, D)),
            "k": _w((lambda *s: torch.randn(*s, dtype=torch.bfloat16) * 0.8)(B, S, D)),
            "v": _w((lambda *s: torch.randn(*s, dtype=torch.bfloat16) * 0.8)(B, S, D)),
            "shift_k": _w((lambda *s: torch.randn(*s, dtype=torch.bfloat16) * 0.8)(D, ks) * 0.5),
            "ssm_k": _w((lambda *s: torch.randn(*s, dtype=torch.bfloat16) * 1.6)(D, S) * (1.0 / S ** 0.5)),
            "ssm_D": _w((lambda *s: torch.randn(*s, dtype=torch.bfloat16) * 0.8)(D)),
        }
    _A_in = _A_setup()

    def _B_setup():
        B, S, Dm, Df = 1, 2048, 512, 1792
        return {
            "x": _w((lambda *s: torch.randn(*s, dtype=torch.bfloat16) * 0.05)(B, S, Dm)),
            "w_gate": _w((lambda *s: torch.randn(*s, dtype=torch.bfloat16) * 0.2)(Dm, Df) * (Dm ** -0.5)),
            "w_up": _w((lambda *s: torch.randn(*s, dtype=torch.bfloat16) * 0.2)(Dm, Df) * (Dm ** -0.5)),
            "w_down": _w((lambda *s: torch.randn(*s, dtype=torch.bfloat16) * 0.2)(Df, Dm) * (Df ** -0.5)),
        }
    _B_in = _B_setup()

    return {
        "A_q": _A_in["q"],
        "A_k": _A_in["k"],
        "A_v": _A_in["v"],
        "A_shift_k": _A_in["shift_k"],
        "A_ssm_k": _A_in["ssm_k"],
        "A_ssm_D": _A_in["ssm_D"],
        "B_x": _B_in["x"],
        "B_w_gate": _B_in["w_gate"],
        "B_w_up": _B_in["w_up"],
        "B_w_down": _B_in["w_down"],
    }

def reference(A_q, A_k, A_v, A_shift_k, A_ssm_k, A_ssm_D, B_x, B_w_gate, B_w_up, B_w_down):
    def _A_ref(q, k, v, shift_k, ssm_k, ssm_D):
        B, S, D = q.shape
        ks = shift_k.shape[-1]
        k_pad = _pad(k, ((0, 0), (ks - 1, 0), (0, 0)))
        k_shift = torch.zeros_like(k)
        for t in range(ks):
            k_shift = k_shift + k_pad[:, t:t + S, :] * shift_k[:, ks - 1 - t][None, None, :]
        kv = k_shift * v
        L = 2 * S
        kv_pad = _pad(kv, ((0, 0), (0, S), (0, 0)))
        kf_pad = _pad(ssm_k, ((0, 0), (0, S)))
        kv_f = (lambda x, axes=(-2,-1): torch.fft.rfft2(x.float(), dim=axes))(kv_pad[:, None, :, :], axes=(1, 2))
        kf_f = (lambda x, axes=(-2,-1): torch.fft.rfft2(x.float(), dim=axes))(kf_pad[:, None, :], axes=(1, 2))
        kf_f = (lambda x, *d: x.permute(*d))(kf_f, 1, 2, 0)
        y_f = kv_f * kf_f[None, :, :, :]
        y = (lambda x, s, axes=(-2,-1): torch.fft.irfft2(x, s=s, dim=axes).to(torch.bfloat16))(y_f, (1, L), axes=(1, 2))[:, 0, :S, :]
        y = y + kv * ssm_D[None, None, :]
        return q * y

    def _B_ref(x, w_gate, w_up, w_down):
        g = torch.einsum("bsd,df->bsf", x, w_gate)
        u = torch.einsum("bsd,df->bsf", x, w_up)
        h = _gelu(g) * u
        return torch.einsum("bsf,fd->bsd", h, w_down)

    x = A_q
    xn = _layernorm(x, axis=-1)
    s = _A_ref(xn, A_k, A_v, A_shift_k, A_ssm_k, A_ssm_D)
    g = _silu(_B_ref(xn, B_w_gate, B_w_up, B_w_down))
    return x + s * g
```

```asm
; @launch grid=(256,1,1) block=(256,1,1) lds=163840
.amdgcn_target "amdgcn-amd-amdhsa--gfx950"
.text
.p2align 12
.globl recurrent_scan__ssm_conv_h3__glu_gated_geglu__prompt_kernel
.p2align 8
.type recurrent_scan__ssm_conv_h3__glu_gated_geglu__prompt_kernel,@function
recurrent_scan__ssm_conv_h3__glu_gated_geglu__prompt_kernel:
    s_load_dwordx2 s[8:9], s[0:1], 0
    s_load_dwordx4 s[36:39], s[0:1], 56
    s_load_dwordx2 s[16:17], s[0:1], 96
    s_load_dwordx4 s[80:83], s[0:1], 8
    s_getpc_b64 s[4:5]
L_pc:
    s_cmp_ge_u32 s2, 256
    s_cbranch_scc1 L_exit
    s_lshr_b32 s91, s2, 3
    v_lshrrev_b32 v4, 4, v0
    s_lshl_b32 s6, s91, 11
    v_lshl_add_u32 v4, v4, 7, s6
    v_min_u32 v4, L_end-L_pc-4, v4
    v_mov_b32 v5, s5
    v_add_co_u32 v4, vcc, s4, v4
    v_lshrrev_b32 v6, 6, v0
    v_and_b32 v1, 63, v0
    v_addc_co_u32 v5, vcc, 0, v5, vcc
    global_load_dword v127, v[4:5], off
    v_readfirstlane_b32 s92, v6
    s_load_dwordx2 s[20:21], s[0:1], 72
    s_load_dwordx2 s[24:25], s[0:1], 32
    s_load_dwordx2 s[28:29], s[0:1], 80
    s_load_dwordx2 s[32:33], s[0:1], 88
    s_load_dwordx2 s[98:99], s[0:1], 40
    s_load_dwordx2 s[42:43], s[0:1], 24
    s_and_b32 s90, s2, 7
    v_lshlrev_b32 v2, 4, v1
    s_mov_b32 s10, 2097152
    s_mov_b32 s11, 0x20000
    s_mov_b32 s15, 0x20000
    s_and_b32 s4, s90, 1
    s_lshr_b32 s5, s90, 1
    s_lshl_b32 s84, s4, 2
    s_add_u32 s86, s84, s5
    s_lshl_b32 s6, s86, 5
    s_add_u32 s6, s6, s91
    s_lshl_b32 s6, s6, 2
    s_add_u32 s6, s6, s92
    s_lshl_b32 s79, s6, 11
    v_lshrrev_b32 v4, 5, v1
    v_and_b32 v5, 31, v1
    v_lshlrev_b32 v96, 10, v4
    v_lshl_add_u32 v96, v5, 4, v96
    v_lshrrev_b32 v6, 3, v1
    v_and_b32 v7, 7, v1
    s_cmp_ge_u32 s91, 28
    s_cbranch_scc1 L_service
    s_and_b32 s6, s91, 3
    s_add_u32 s84, s84, s6
    s_mul_i32 s85, s5, 7
    s_lshr_b32 s6, s91, 2
    s_add_u32 s85, s85, s6
    v_lshrrev_b32 v98, 4, v1
    s_lshr_b32 s4, s92, 1
    s_and_b32 s6, s92, 1
    v_and_b32 v99, 1, v98
    v_lshlrev_b32 v99, 1, v99
    v_xor_b32 v99, v7, v99
    v_mul_u32_u24 v100, 3584, v6
    v_lshl_add_u32 v99, v99, 4, v100
    s_mul_i32 s6, s6, 114688
    s_lshl_b32 s7, s85, 7
    s_add_u32 s6, s6, s7
    v_add_u32 v16, s6, v99
    v_xor_b32 v99, 64, v16
    v_add_u32 v17, 27648, v99
    v_add_u32 v18, 55296, v16
    v_add_u32 v19, 82944, v99
    s_lshl_b32 s76, s84, 2
    s_add_u32 s76, s76, s92
    s_lshl_b32 s7, s76, 16
    v_xor_b32 v99, v7, v98
    v_lshlrev_b32 v99, 4, v99
    v_lshl_add_u32 v99, v6, 10, v99
    v_add_u32 v8, s7, v99
    v_xor_b32 v99, 64, v8
    v_add_u32 v9, 7168, v99
    v_add_u32 v10, 14336, v8
    v_add_u32 v11, 21504, v99
    v_add_u32 v12, 32768, v8
    v_add_u32 v13, 39936, v99
    v_add_u32 v14, 47104, v8
    v_add_u32 v15, 54272, v99
    s_lshl_b32 s44, s92, 13
    s_lshl_b32 s45, s92, 12
    s_add_u32 s45, s45, 32768
    s_lshl_b32 s46, s84, 7
    s_mov_b32 s14, 1835008
    s_cmp_eq_u32 s4, 0
    s_waitcnt lgkmcnt(0)
    s_cselect_b32 s12, s36, s38
    s_cselect_b32 s13, s37, s39
    buffer_load_dwordx4 v[64:67], v96, s[8:11], s79 offen
    buffer_load_dwordx4 v[68:71], v96, s[8:11], s79 offen offset:512
    s_add_u32 m0, s45, 49152
    s_mul_i32 s47, s46, 1792
    buffer_load_dwordx4 v16, s[12:15], s47 offen offset:0 lds
    buffer_load_dwordx4 v17, s[12:15], s47 offen offset:1024 lds
    buffer_load_dwordx4 v18, s[12:15], s47 offen offset:2048 lds
    buffer_load_dwordx4 v19, s[12:15], s47 offen offset:3072 lds
    s_add_u32 m0, s44, 49152
    s_nop 0
    buffer_load_dwordx4 v8, s[8:11], s46 offen offset:0 lds
    s_mov_b32 s42, 0x76543210
    s_mov_b32 s43, s42
    s_lshl_b32 s4, s84, 2
    s_lshr_b64 s[42:43], s[42:43], s4
    s_and_b32 s4, s91, 28
    s_add_u32 s4, s4, 4
    s_lshr_b32 s5, s42, 4
    s_xor_b32 s5, s5, s42
    s_lshr_b32 s5, s5, s4
    s_and_b32 s5, s5, 7
    s_mul_i32 s5, s5, 17
    s_lshl_b32 s5, s5, s4
    s_cmp_lt_u32 s4, 28
    s_cselect_b32 s5, s5, 0
    s_xor_b32 s42, s42, s5
    v_lshrrev_b32 v102, 4, v1
    v_and_b32 v103, 15, v1
    v_bfe_u32 v98, v1, 1, 3
    v_xor_b32 v98, v102, v98
    v_lshlrev_b32 v98, 4, v98
    v_lshl_add_u32 v98, v103, 7, v98
    s_lshl_b32 s4, s92, 13
    v_add_u32 v22, s4, v98
    v_xor_b32 v23, 64, v22
    v_add_u32 v20, 98304, v22
    v_add_u32 v21, 98304, v23
    v_and_b32 v99, 3, v6
    v_bfe_u32 v100, v1, 2, 2
    v_lshlrev_b32 v98, 10, v102
    v_lshl_add_u32 v98, v100, 7, v98
    v_and_b32 v101, 3, v1
    v_lshl_add_u32 v98, v101, 3, v98
    v_lshl_add_u32 v98, v99, 5, v98
    v_add_u32 v28, 32768, v98
    v_xor_b32 v29, 32, v28
    v_xor_b32 v30, 64, v28
    v_xor_b32 v31, 96, v28
    v_add_u32 v24, 98304, v28
    v_add_u32 v25, 98304, v29
    v_add_u32 v26, 98304, v30
    v_add_u32 v27, 98304, v31
    s_lshl_b32 s4, s92, 5
    v_xor_b32 v35, s4, v28
    s_lshl_b32 s4, s76, 2
    s_lshr_b32 s5, s90, 1
    s_add_u32 s4, s4, s5
    s_lshl_b32 s4, s4, 7
    s_add_u32 s56, s4, 16252928
    s_lshl_b32 s5, s85, 1
    s_mul_i32 s4, s76, 224
    s_add_u32 s4, s4, s5
    s_lshl_b32 s48, s4, 10
    s_add_u32 s49, s48, 114688
    v_add_u32 v32, 57344, v2
    s_lshl_b32 s76, s76, 10
    s_add_u32 s76, s76, 15990784
    v_and_b32 v98, 8, v103
    v_add_lshl_u32 v34, v98, v103, 3
    v_lshlrev_b32 v33, 31, v4
    v_lshl_add_u32 v33, v5, 2, v33
    s_lshl_b32 s6, s85, 12
    s_add_u32 s6, s6, 16056320
    s_lshl_b32 s4, s92, 10
    s_add_u32 s36, s6, s4
    s_add_u32 s38, s4, 159744
    s_lshl_b32 s4, s84, 7
    s_add_u32 s37, s36, s4
    s_mov_b32 s18, 16777216
    s_mov_b32 s19, 0x20000
    s_mov_b32 s22, 1835008
    s_mov_b32 s23, 0x20000
    s_mov_b32 s26, 2097152
    s_mov_b32 s27, 0x20000
    s_mov_b32 s30, 2097152
    s_mov_b32 s31, 0x20000
    s_mov_b32 s34, 256
    s_mov_b32 s35, 0x20000
    v_cmp_eq_u32 vcc, 0, v1
    s_lshl_b32 s86, s86, 2
    s_and_b32 s4, s91, 3
    v_bfrev_b32 v62, 1
    v_lshlrev_b32 v61, 3, v1
    v_cndmask_b32 v62, v62, 0, vcc
    s_add_u32 s86, s86, s4
    s_lshr_b32 s4, s91, 2
    s_xor_b32 s87, s4, 4
    s_lshr_b32 s4, s4, 2
    s_and_b32 s5, s90, 1
    s_lshl_b32 s5, s5, 1
    s_add_u32 s4, s4, s5
    s_lshl_b32 s4, s4, 2
    s_add_u32 s4, s4, s92
    s_lshl_b32 s4, s4, 10
    s_add_u32 s60, s4, 16515072
    s_lshr_b32 s4, s92, 1
    s_and_b32 s77, s92, 1
    s_lshl_b32 s5, s90, 5
    s_add_u32 s5, s5, s91
    s_lshl_b32 s5, s5, 1
    s_add_u32 s5, s5, s4
    s_lshl_b32 s6, s77, 9
    s_add_u32 s6, s6, s5
    s_lshr_b32 s6, s6, 4
    s_lshl_b32 s6, s6, 7
    s_add_u32 s57, s6, 16384000
    s_mov_b32 s82, 0
    s_add_u32 s83, s91, 4
    s_and_b32 s83, s83, 24
    s_cbranch_scc1 L_clr_1
    s_atomic_and s82, s[16:17], s56
L_clr_1:
    s_and_b32 s83, s5, 15
    s_cbranch_scc1 L_clr_2
    s_atomic_and s82, s[16:17], s57
L_clr_2:
    s_lshl_b32 s66, s5, 12
    s_lshl_b32 s6, s77, 11
    s_mul_i32 s67, s5, 4224
    s_add_u32 s65, s67, 8388608
    s_add_u32 s67, s67, s6
    s_add_u32 s67, s67, 13631488
    s_lshl_b32 s5, s5, 1
    v_mov_b32 v63, s5
    v_mov_b32 v36, s66
    s_add_u32 s66, s66, s6
    s_add_u32 s89, s66, 2
    s_mul_i32 s7, s4, 4352
    s_add_u32 s7, s7, 147472
    s_mul_i32 s4, s4, 22784
    s_add_u32 s4, s4, 98320
    s_mul_i32 s5, s77, 9288
    s_sub_u32 s63, s4, s5
    s_add_u32 s64, s4, s6
    s_add_u32 s64, s64, 18672
    s_add_u32 s41, s7, s6
    s_add_u32 s41, s41, 116
    v_lshl_add_u32 v56, v1, 2, s63
    s_sub_u32 s93, s7, s4
    s_sub_u32 s93, s93, 18560
    s_add_u32 s5, s77, 27
    v_min_u32 v57, s5, v1
    s_mul_i32 s5, s77, s93
    s_add_u32 s5, s5, s4
    s_add_u32 s5, s5, 18560
    v_lshl_add_u32 v57, v57, 2, s5
    s_sub_u32 s5, s4, s6
    s_add_u32 s5, s5, 16464
    v_and_b32 v60, -16, v61
    v_sub_u32 v60, s5, v60
    s_lshl_b32 s5, s77, 8
    s_add_u32 s4, s4, s5
    s_add_u32 s7, s7, s5
    v_lshrrev_b32 v98, 4, v1
    v_and_b32 v125, 3, v1
    v_bfe_u32 v99, v1, 2, 2
    v_mul_u32_u24 v54, 4640, v125
    v_lshlrev_b32 v100, 7, v99
    v_sub_u32 v54, v54, v100
    v_lshl_add_u32 v54, v98, 4, v54
    s_add_u32 s5, s4, 384
    v_add_u32 v54, s5, v54
    v_and_b32 v126, 1, v1
    v_mul_u32_u24 v55, s93, v126
    v_sub_u32 v55, s7, v55
    v_bfe_u32 v101, v1, 1, 3
    v_add_u32 v101, v101, v98
    v_lshl_add_u32 v55, v101, 4, v55
    v_mul_u32_u24 v37, 0x202, v126
    v_sub_u32 v37, 0x302, v37
    v_lshlrev_b32 v37, 16, v37
    v_or_b32 v37, 0xc0c, v37
    v_lshlrev_b32 v126, 7, v4
    s_mul_i32 s61, s92, 12288
    s_add_u32 s5, s61, 57344
    v_add_u32 v58, s5, v2
    s_xor_b32 s5, s92, 1
    s_mul_i32 s5, s5, 12288
    s_add_u32 s5, s5, 57344
    v_add_u32 v59, s5, v2
    v_lshlrev_b32 v102, 1, v98
    v_xor_b32 v102, v7, v102
    v_lshlrev_b32 v102, 4, v102
    v_lshl_add_u32 v48, v6, 10, v102
    s_mul_i32 s6, s92, 458752
    s_lshl_b32 s5, s87, 7
    s_add_u32 s6, s6, s5
    v_add_u32 v48, s6, v48
    v_add_u32 v49, 7168, v48
    v_add_u32 v50, 14336, v48
    v_add_u32 v51, 21504, v48
    s_bfe_u32 s6, s86, 0x10001
    s_mul_i32 s6, s6, 3
    s_xor_b32 s7, s87, 3
    s_min_u32 s7, s7, 1
    s_sub_u32 s7, 1, s7
    s_mul_i32 s6, s6, s7
    s_xor_b32 s93, s86, s87
    s_and_b32 s93, s93, 1
    s_mul_i32 s93, s93, 7
    buffer_load_dwordx4 v9, s[8:11], s46 offen offset:1024 lds
    s_add_u32 s6, s6, s93
    s_min_u32 s7, s90, 6
    s_add_u32 s93, s6, s7
    s_sub_u32 s7, s93, 14
    s_min_u32 s93, s93, s7
    s_lshl_b32 s93, s93, 15
    s_mov_b32 s62, s93
    buffer_load_dwordx4 v10, s[8:11], s46 offen offset:2048 lds
    v_lshl_add_u32 v52, v98, 9, v100
    v_lshl_add_u32 v52, v125, 3, v52
    v_and_b32 v102, 3, v6
    v_lshl_add_u32 v52, v102, 5, v52
    v_add_u32 v52, s61, v52
    v_xor_b32 v53, 32, v52
    v_xor_b32 v62, 64, v52
    buffer_load_dwordx4 v11, s[8:11], s46 offen offset:3072 lds
    s_add_u32 m0, s44, 53248
    v_xor_b32 v123, 96, v52
    s_lshl_b32 s88, s92, 12
    s_add_u32 s88, s88, 147456
    v_lshlrev_b32 v125, 7, v6
    s_mov_b64 exec, 0
    s_cmp_lg_u32 s92, 0
    s_cbranch_scc1 L_w_4
    s_call_b64 s[6:7], L_pad0
    s_branch L_visited_3
L_w_4:
    s_cmp_lg_u32 s92, 1
    s_cbranch_scc1 L_w_5
    s_call_b64 s[6:7], L_return
    s_branch L_visited_3
L_w_5:
    s_cmp_lg_u32 s92, 2
    s_cbranch_scc1 L_w_6
    s_call_b64 s[6:7], L_return
    s_branch L_visited_3
L_w_6:
    s_call_b64 s[6:7], L_return
L_visited_3:
    s_mov_b64 exec, -1
    s_waitcnt vmcnt(8)
    v_lshlrev_b32 v72, 16, v64
    buffer_load_dwordx4 v12, s[8:11], s46 offen offset:0 lds
    v_and_b32 v73, 0xffff0000, v64
    v_lshlrev_b32 v74, 16, v65
    v_and_b32 v75, 0xffff0000, v65
    v_lshlrev_b32 v76, 16, v66
    v_and_b32 v77, 0xffff0000, v66
    v_lshlrev_b32 v78, 16, v67
    v_and_b32 v79, 0xffff0000, v67
    buffer_load_dwordx4 v13, s[8:11], s46 offen offset:1024 lds
    v_lshlrev_b32 v80, 16, v68
    v_and_b32 v81, 0xffff0000, v68
    v_lshlrev_b32 v82, 16, v69
    v_and_b32 v83, 0xffff0000, v69
    v_lshlrev_b32 v84, 16, v70
    v_and_b32 v85, 0xffff0000, v70
    buffer_load_dwordx4 v14, s[8:11], s46 offen offset:2048 lds
    v_lshlrev_b32 v86, 16, v71
    v_and_b32 v87, 0xffff0000, v71
    v_pk_add_f32 v[88:89], v[72:73], v[74:75]
    v_pk_add_f32 v[88:89], v[88:89], v[76:77]
    v_pk_add_f32 v[88:89], v[88:89], v[78:79]
    v_pk_add_f32 v[88:89], v[88:89], v[80:81]
    v_pk_add_f32 v[88:89], v[88:89], v[82:83]
    buffer_load_dwordx4 v15, s[8:11], s46 offen offset:3072 lds
    s_bfe_u32 s46, s42, 196612
    s_lshl_b32 s46, s46, 7
    v_pk_add_f32 v[88:89], v[88:89], v[84:85]
    v_pk_add_f32 v[88:89], v[88:89], v[86:87]
    v_add_f32 v88, v88, v89
    s_nop 1
    v_add_f32_dpp v88, v88, v88 quad_perm:[1,0,3,2] row_mask:0xf bank_mask:0xf
    s_nop 1
    v_add_f32_dpp v88, v88, v88 quad_perm:[2,3,0,1] row_mask:0xf bank_mask:0xf
    s_add_u32 m0, s45, 98304
    s_mul_i32 s47, s46, 1792
    buffer_load_dwordx4 v16, s[12:15], s47 offen offset:0 lds
    s_nop 1
    v_add_f32_dpp v88, v88, v88 row_half_mirror row_mask:0xf bank_mask:0xf
    s_nop 1
    v_add_f32_dpp v88, v88, v88 row_mirror row_mask:0xf bank_mask:0xf
    v_mov_b32 v89, v88
    s_nop 1
    v_permlane16_swap_b32 v89, v88
    buffer_load_dwordx4 v17, s[12:15], s47 offen offset:1024 lds
    s_nop 0
    v_add_f32 v88, v89, v88
    v_mul_f32 v88, 0x3b000000, v88
    v_pk_add_f32 v[72:73], v[72:73], v[88:89] op_sel_hi:[1,0] neg_lo:[0,1] neg_hi:[0,1]
    v_pk_add_f32 v[74:75], v[74:75], v[88:89] op_sel_hi:[1,0] neg_lo:[0,1] neg_hi:[0,1]
    v_pk_add_f32 v[76:77], v[76:77], v[88:89] op_sel_hi:[1,0] neg_lo:[0,1] neg_hi:[0,1]
    buffer_load_dwordx4 v18, s[12:15], s47 offen offset:2048 lds
    v_pk_add_f32 v[78:79], v[78:79], v[88:89] op_sel_hi:[1,0] neg_lo:[0,1] neg_hi:[0,1]
    v_pk_add_f32 v[80:81], v[80:81], v[88:89] op_sel_hi:[1,0] neg_lo:[0,1] neg_hi:[0,1]
    v_pk_add_f32 v[82:83], v[82:83], v[88:89] op_sel_hi:[1,0] neg_lo:[0,1] neg_hi:[0,1]
    v_pk_add_f32 v[84:85], v[84:85], v[88:89] op_sel_hi:[1,0] neg_lo:[0,1] neg_hi:[0,1]
    v_pk_add_f32 v[86:87], v[86:87], v[88:89] op_sel_hi:[1,0] neg_lo:[0,1] neg_hi:[0,1]
    v_pk_mul_f32 v[90:91], v[72:73], v[72:73]
    v_pk_fma_f32 v[90:91], v[74:75], v[74:75], v[90:91]
    buffer_load_dwordx4 v19, s[12:15], s47 offen offset:3072 lds
    s_add_u32 m0, s44, 98304
    v_pk_fma_f32 v[90:91], v[76:77], v[76:77], v[90:91]
    v_mov_b32 v144, 0x3f803f80
    v_mov_b32 v145, 0x3f803f80
    v_mov_b32 v146, 0x3f803f80
    v_mov_b32 v147, 0x3f803f80
    s_waitcnt vmcnt(12)
    s_barrier
    ds_read_b64_tr_b16 v[128:129], v35 offset:49152
    ds_read_b64_tr_b16 v[130:131], v35 offset:49664
    ds_read_b64_tr_b16 v[132:133], v35 offset:53248
    ds_read_b64_tr_b16 v[134:135], v35 offset:53760
    ds_read_b64_tr_b16 v[136:137], v35 offset:57344
    ds_read_b64_tr_b16 v[138:139], v35 offset:57856
    ds_read_b64_tr_b16 v[140:141], v35 offset:61440
    ds_read_b64_tr_b16 v[142:143], v35 offset:61952
    v_pk_fma_f32 v[90:91], v[78:79], v[78:79], v[90:91]
    v_pk_fma_f32 v[90:91], v[80:81], v[80:81], v[90:91]
    v_pk_fma_f32 v[90:91], v[82:83], v[82:83], v[90:91]
    v_pk_fma_f32 v[90:91], v[84:85], v[84:85], v[90:91]
    v_pk_fma_f32 v[90:91], v[86:87], v[86:87], v[90:91]
    buffer_load_dwordx4 v8, s[8:11], s46 offen offset:0 lds
    v_add_f32 v89, v90, v91
    s_nop 1
    v_add_f32_dpp v89, v89, v89 quad_perm:[1,0,3,2] row_mask:0xf bank_mask:0xf
    s_nop 1
    v_add_f32_dpp v89, v89, v89 quad_perm:[2,3,0,1] row_mask:0xf bank_mask:0xf
    s_nop 1
    v_add_f32_dpp v89, v89, v89 row_half_mirror row_mask:0xf bank_mask:0xf
    buffer_load_dwordx4 v9, s[8:11], s46 offen offset:1024 lds
    s_nop 1
    v_add_f32_dpp v89, v89, v89 row_mirror row_mask:0xf bank_mask:0xf
    v_mov_b32 v90, v89
    s_nop 1
    s_waitcnt lgkmcnt(0)
    v_mfma_f32_16x16x32_bf16 v[148:151], v[144:147], v[128:131], 0
    v_mfma_f32_16x16x32_bf16 v[148:151], v[144:147], v[132:135], v[148:151]
    v_mfma_f32_16x16x32_bf16 v[152:155], v[144:147], v[136:139], 0
    v_mfma_f32_16x16x32_bf16 v[152:155], v[144:147], v[140:143], v[152:155]
    v_permlane16_swap_b32 v90, v89
    s_nop 0
    buffer_load_dwordx4 v10, s[8:11], s46 offen offset:2048 lds
    v_add_f32 v89, v90, v89
    v_mul_f32 v89, 0x3b000000, v89
    v_cvt_pk_bf16_f32 v88, v88, v88
    v_and_b32 v88, 0xffff0000, v88
    v_cvt_pk_bf16_f32 v89, v89, v89
    v_and_b32 v89, 0xffff0000, v89
    buffer_load_dwordx4 v11, s[8:11], s46 offen offset:3072 lds
    s_add_u32 m0, s44, 102400
    v_add_f32 v89, 0x3727c5ac, v89
    v_cvt_pk_bf16_f32 v89, v89, v89
    v_and_b32 v89, 0xffff0000, v89
    v_sqrt_f32 v89, v89
    s_lshr_b32 s79, s79, 13
    s_lshl_b32 s79, s79, 7
    s_add_u32 s79, s79, 15990784
    buffer_load_dwordx4 v12, s[8:11], s46 offen offset:0 lds
    s_lshl_b32 s78, s92, 4
    v_lshl_add_u32 v90, v4, 3, s78
    v_add_u32 v90, 147456, v90
    v_and_b32 v46, 48, v2
    v_add_u32 v46, 147456, v46
    v_or_b32 v47, s92, v6
    v_min_u32 v47, 1, v47
    buffer_load_dwordx4 v13, s[8:11], s46 offen offset:1024 lds
    v_lshlrev_b32 v47, 31, v47
    v_or_b32 v47, v47, v2
    v_cvt_pk_bf16_f32 v89, v89, v89
    v_and_b32 v89, 0xffff0000, v89
    ds_write_b64 v90, v[88:89]
    v_cmp_gt_u32 s[4:5], 16, v1
    v_and_b32 v35, 15, v1
    buffer_load_dwordx4 v14, s[8:11], s46 offen offset:2048 lds
    v_lshlrev_b32 v35, 2, v35
    v_lshl_add_u32 v35, v4, 6, v35
    v_bfe_u32 v150, v1, 4, 1
    v_lshl_add_u32 v35, v150, 10, v35
    v_add_u32 v35, 159744, v35
    v_cndmask_b32 v44, v152, v148, s[4:5]
    buffer_load_dwordx4 v15, s[8:11], s46 offen offset:3072 lds
    s_bfe_u32 s46, s42, 196616
    s_lshl_b32 s46, s46, 7
    s_branch L_main
L_return:
    s_setpc_b64 s[6:7]
.p2align 12
L_main:
L_pad0:
    s_cbranch_execz L_return
    s_waitcnt vmcnt(12) lgkmcnt(0)
    s_barrier
    ds_read_b128 v[40:43], v46
    ds_read_b64_tr_b16 v[80:81], v28 offset:49152
    ds_read_b64_tr_b16 v[82:83], v28 offset:49664
    ds_read_b128 v[64:67], v22 offset:49152
    ds_read_b128 v[68:71], v22 offset:51200
    ds_read_b128 v[72:75], v22 offset:53248
    ds_read_b128 v[76:79], v22 offset:55296
    ds_read_b64_tr_b16 v[84:85], v28 offset:57344
    ds_read_b64_tr_b16 v[86:87], v28 offset:57856
    ds_read_b64_tr_b16 v[88:89], v29 offset:49152
    ds_read_b64_tr_b16 v[90:91], v29 offset:49664
    ds_read_b64_tr_b16 v[92:93], v29 offset:57344
    ds_read_b64_tr_b16 v[94:95], v29 offset:57856
    ds_read_b64_tr_b16 v[96:97], v30 offset:49152
    ds_read_b64_tr_b16 v[98:99], v30 offset:49664
    ds_read_b64_tr_b16 v[100:101], v30 offset:57344
    ds_read_b64_tr_b16 v[102:103], v30 offset:57856
    ds_read_b64_tr_b16 v[104:105], v31 offset:49152
    ds_read_b64_tr_b16 v[106:107], v31 offset:49664
    ds_read_b64_tr_b16 v[108:109], v31 offset:57344
    ds_read_b64_tr_b16 v[110:111], v31 offset:57856
    s_waitcnt lgkmcnt(0)
    v_mfma_f32_16x16x32_bf16 v[128:131], v[80:83], v[64:67], 0
    ds_read_b64_tr_b16 a[176:177], v28 offset:53248
    v_mfma_f32_16x16x32_bf16 v[160:163], v[80:83], v[68:71], 0
    ds_read_b64_tr_b16 a[178:179], v28 offset:53760
    v_mfma_f32_16x16x32_bf16 v[192:195], v[80:83], v[72:75], 0
    buffer_store_dword v44, v33, s[16:19], s37 offen sc1
    v_mfma_f32_16x16x32_bf16 v[224:227], v[80:83], v[76:79], 0
    ds_read_b128 a[160:163], v23 offset:49152
    s_waitcnt lgkmcnt(14)
    v_mfma_f32_16x16x32_bf16 v[136:139], v[84:87], v[64:67], 0
    ds_read_b128 a[164:167], v23 offset:51200
    v_mfma_f32_16x16x32_bf16 v[168:171], v[84:87], v[68:71], 0
    buffer_store_dwordx4 v[40:43], v47, s[16:19], s79 offen sc1
    v_mfma_f32_16x16x32_bf16 v[200:203], v[84:87], v[72:75], 0
    ds_read_b128 a[168:171], v23 offset:53248
    s_add_u32 m0, s45, 0
    v_mfma_f32_16x16x32_bf16 v[232:235], v[84:87], v[76:79], 0
    ds_read_b128 a[172:175], v23 offset:55296
    s_mul_i32 s47, s46, 1792
    v_mfma_f32_16x16x32_bf16 v[132:135], v[88:91], v[64:67], 0
    ds_read_b64_tr_b16 a[180:181], v28 offset:61440
    v_mfma_f32_16x16x32_bf16 v[164:167], v[88:91], v[68:71], 0
    buffer_load_dwordx4 v16, s[12:15], s47 offen offset:0 lds
    v_mfma_f32_16x16x32_bf16 v[196:199], v[88:91], v[72:75], 0
    ds_read_b64_tr_b16 a[182:183], v28 offset:61952
    v_mfma_f32_16x16x32_bf16 v[228:231], v[88:91], v[76:79], 0
    ds_read_b64_tr_b16 a[184:185], v29 offset:53248
    v_mfma_f32_16x16x32_bf16 v[140:143], v[92:95], v[64:67], 0
    ds_read_b64_tr_b16 a[186:187], v29 offset:53760
    v_mfma_f32_16x16x32_bf16 v[172:175], v[92:95], v[68:71], 0
    buffer_load_dwordx4 v17, s[12:15], s47 offen offset:1024 lds
    v_mfma_f32_16x16x32_bf16 v[204:207], v[92:95], v[72:75], 0
    ds_read_b64_tr_b16 a[188:189], v29 offset:61440
    v_mfma_f32_16x16x32_bf16 v[236:239], v[92:95], v[76:79], 0
    ds_read_b64_tr_b16 a[190:191], v29 offset:61952
    v_mfma_f32_16x16x32_bf16 v[144:147], v[96:99], v[64:67], 0
    buffer_load_dwordx4 v18, s[12:15], s47 offen offset:2048 lds
    v_mfma_f32_16x16x32_bf16 v[176:179], v[96:99], v[68:71], 0
    ds_read_b64_tr_b16 a[192:193], v30 offset:53248
    v_mfma_f32_16x16x32_bf16 v[208:211], v[96:99], v[72:75], 0
    ds_read_b64_tr_b16 a[194:195], v30 offset:53760
    v_mfma_f32_16x16x32_bf16 v[240:243], v[96:99], v[76:79], 0
    ds_read_b64_tr_b16 a[196:197], v30 offset:61440
    v_mfma_f32_16x16x32_bf16 v[152:155], v[100:103], v[64:67], 0
    buffer_load_dwordx4 v19, s[12:15], s47 offen offset:3072 lds
    s_add_u32 m0, s44, 0
    v_mfma_f32_16x16x32_bf16 v[184:187], v[100:103], v[68:71], 0
    ds_read_b64_tr_b16 a[198:199], v30 offset:61952
    v_mfma_f32_16x16x32_bf16 v[216:219], v[100:103], v[72:75], 0
    ds_read_b64_tr_b16 a[200:201], v31 offset:53248
    v_mfma_f32_16x16x32_bf16 v[248:251], v[100:103], v[76:79], 0
    ds_read_b64_tr_b16 a[202:203], v31 offset:53760
    v_mfma_f32_16x16x32_bf16 v[148:151], v[104:107], v[64:67], 0
    buffer_load_dwordx4 v8, s[8:11], s46 offen offset:0 lds
    v_mfma_f32_16x16x32_bf16 v[180:183], v[104:107], v[68:71], 0
    ds_read_b64_tr_b16 a[204:205], v31 offset:61440
    v_mfma_f32_16x16x32_bf16 v[212:215], v[104:107], v[72:75], 0
    ds_read_b64_tr_b16 a[206:207], v31 offset:61952
    v_mfma_f32_16x16x32_bf16 v[244:247], v[104:107], v[76:79], 0
    buffer_load_dwordx4 v9, s[8:11], s46 offen offset:1024 lds
    v_mfma_f32_16x16x32_bf16 v[156:159], v[108:111], v[64:67], 0
    v_mfma_f32_16x16x32_bf16 v[188:191], v[108:111], v[68:71], 0
    buffer_load_dwordx4 v10, s[8:11], s46 offen offset:2048 lds
    v_mfma_f32_16x16x32_bf16 v[220:223], v[108:111], v[72:75], 0
    v_mfma_f32_16x16x32_bf16 v[252:255], v[108:111], v[76:79], 0
    s_waitcnt vmcnt(9) lgkmcnt(0)
    s_barrier
    v_mfma_f32_16x16x32_bf16 v[128:131], a[176:179], a[160:163], v[128:131]
    ds_read_b64_tr_b16 v[80:81], v24 offset:0
    s_sub_u32 s6, s88, s61
    v_add_u32 v43, s6, v52
    v_add_u32 v44, s6, v53
    v_add_u32 v45, s6, v62
    v_add_u32 v46, s6, v123
    s_add_u32 s6, s93, 32768
    s_sub_u32 s7, s6, 458752
    s_min_u32 s0, s6, s7
    s_add_u32 s6, s93, 65536
    s_sub_u32 s7, s6, 458752
    s_min_u32 s1, s6, s7
    s_add_u32 s6, s93, 98304
    s_sub_u32 s7, s6, 458752
    s_min_u32 s3, s6, s7
    s_add_u32 s6, s93, 131072
    s_sub_u32 s7, s6, 458752
    s_min_u32 s39, s6, s7
    s_add_u32 s6, s93, 163840
    s_sub_u32 s7, s6, 458752
    s_min_u32 s40, s6, s7
    s_add_u32 s6, s93, 196608
    s_sub_u32 s7, s6, 458752
    s_min_u32 s50, s6, s7
    s_add_u32 s6, s93, 229376
    s_sub_u32 s7, s6, 458752
    s_min_u32 s51, s6, s7
    s_add_u32 s6, s93, 262144
    s_sub_u32 s7, s6, 458752
    s_min_u32 s52, s6, s7
    s_add_u32 s6, s93, 294912
    s_sub_u32 s7, s6, 458752
    s_min_u32 s53, s6, s7
    s_add_u32 s6, s93, 327680
    s_sub_u32 s7, s6, 458752
    s_min_u32 s54, s6, s7
    s_add_u32 s6, s93, 360448
    s_sub_u32 s7, s6, 458752
    s_min_u32 s55, s6, s7
    s_add_u32 s6, s93, 393216
    s_sub_u32 s7, s6, 458752
    s_min_u32 s80, s6, s7
    s_add_u32 s6, s93, 425984
    s_sub_u32 s7, s6, 458752
    s_min_u32 s81, s6, s7
    s_lshl_b32 s5, s87, 7
    s_and_b32 s6, s87, 0
    s_lshl_b32 s7, s86, 1
    s_add_u32 s7, s7, s6
    s_lshl_b32 s70, s7, 15
    s_add_u32 s70, s70, s5
    s_xor_b32 s71, s70, 0x8000
    s_lshl_b32 s72, s7, 9
    s_add_u32 s72, s72, 15990784
    v_mfma_f32_16x16x32_bf16 v[160:163], a[176:179], a[164:167], v[160:163]
    ds_read_b64_tr_b16 v[82:83], v24 offset:512
    v_mfma_f32_16x16x32_bf16 v[192:195], a[176:179], a[168:171], v[192:195]
    buffer_load_dwordx4 v11, s[8:11], s46 offen offset:3072 lds
    v_mfma_f32_16x16x32_bf16 v[224:227], a[176:179], a[172:175], v[224:227]
    ds_read_b128 v[64:67], v20 offset:0
    s_add_u32 m0, s44, 4096
    v_mfma_f32_16x16x32_bf16 v[136:139], a[180:183], a[160:163], v[136:139]
    ds_read_b128 v[68:71], v20 offset:2048
    v_mfma_f32_16x16x32_bf16 v[168:171], a[180:183], a[164:167], v[168:171]
    ds_read_b128 v[72:75], v20 offset:4096
    v_mfma_f32_16x16x32_bf16 v[200:203], a[180:183], a[168:171], v[200:203]
    buffer_load_dwordx4 v12, s[8:11], s46 offen offset:0 lds
    v_mfma_f32_16x16x32_bf16 v[232:235], a[180:183], a[172:175], v[232:235]
    ds_read_b128 v[76:79], v20 offset:6144
    v_mfma_f32_16x16x32_bf16 v[132:135], a[184:187], a[160:163], v[132:135]
    ds_read_b64_tr_b16 v[84:85], v24 offset:8192
    v_mfma_f32_16x16x32_bf16 v[164:167], a[184:187], a[164:167], v[164:167]
    ds_read_b64_tr_b16 v[86:87], v24 offset:8704
    v_mfma_f32_16x16x32_bf16 v[196:199], a[184:187], a[168:171], v[196:199]
    buffer_load_dwordx4 v13, s[8:11], s46 offen offset:1024 lds
    v_mfma_f32_16x16x32_bf16 v[228:231], a[184:187], a[172:175], v[228:231]
    ds_read_b64_tr_b16 v[88:89], v25 offset:0
    v_mfma_f32_16x16x32_bf16 v[140:143], a[188:191], a[160:163], v[140:143]
    ds_read_b64_tr_b16 v[90:91], v25 offset:512
    v_mfma_f32_16x16x32_bf16 v[172:175], a[188:191], a[164:167], v[172:175]
    ds_read_b64_tr_b16 v[92:93], v25 offset:8192
    v_mfma_f32_16x16x32_bf16 v[204:207], a[188:191], a[168:171], v[204:207]
    buffer_load_dwordx4 v14, s[8:11], s46 offen offset:2048 lds
    v_mfma_f32_16x16x32_bf16 v[236:239], a[188:191], a[172:175], v[236:239]
    ds_read_b64_tr_b16 v[94:95], v25 offset:8704
    v_mfma_f32_16x16x32_bf16 v[144:147], a[192:195], a[160:163], v[144:147]
    ds_read_b64_tr_b16 v[96:97], v26 offset:0
    v_mfma_f32_16x16x32_bf16 v[176:179], a[192:195], a[164:167], v[176:179]
    ds_read_b64_tr_b16 v[98:99], v26 offset:512
    v_mfma_f32_16x16x32_bf16 v[208:211], a[192:195], a[168:171], v[208:211]
    buffer_load_dwordx4 v15, s[8:11], s46 offen offset:3072 lds
    s_bfe_u32 s46, s42, 196620
    v_mfma_f32_16x16x32_bf16 v[240:243], a[192:195], a[172:175], v[240:243]
    ds_read_b64_tr_b16 v[100:101], v26 offset:8192
    s_lshl_b32 s46, s46, 7
    v_mfma_f32_16x16x32_bf16 v[152:155], a[196:199], a[160:163], v[152:155]
    ds_read_b64_tr_b16 v[102:103], v26 offset:8704
    s_add_u32 m0, s45, 49152
    v_mfma_f32_16x16x32_bf16 v[184:187], a[196:199], a[164:167], v[184:187]
    ds_read_b64_tr_b16 v[104:105], v27 offset:0
    s_mul_i32 s47, s46, 1792
    v_mfma_f32_16x16x32_bf16 v[216:219], a[196:199], a[168:171], v[216:219]
    buffer_load_dwordx4 v16, s[12:15], s47 offen offset:0 lds
    v_mfma_f32_16x16x32_bf16 v[248:251], a[196:199], a[172:175], v[248:251]
    ds_read_b64_tr_b16 v[106:107], v27 offset:512
    v_mfma_f32_16x16x32_bf16 v[148:151], a[200:203], a[160:163], v[148:151]
    ds_read_b64_tr_b16 v[108:109], v27 offset:8192
    v_mfma_f32_16x16x32_bf16 v[180:183], a[200:203], a[164:167], v[180:183]
    ds_read_b64_tr_b16 v[110:111], v27 offset:8704
    v_mfma_f32_16x16x32_bf16 v[212:215], a[200:203], a[168:171], v[212:215]
    buffer_load_dwordx4 v17, s[12:15], s47 offen offset:1024 lds
    v_mfma_f32_16x16x32_bf16 v[244:247], a[200:203], a[172:175], v[244:247]
    v_mfma_f32_16x16x32_bf16 v[156:159], a[204:207], a[160:163], v[156:159]
    v_mfma_f32_16x16x32_bf16 v[188:191], a[204:207], a[164:167], v[188:191]
    buffer_load_dwordx4 v18, s[12:15], s47 offen offset:2048 lds
    v_mfma_f32_16x16x32_bf16 v[220:223], a[204:207], a[168:171], v[220:223]
    v_mfma_f32_16x16x32_bf16 v[252:255], a[204:207], a[172:175], v[252:255]
    s_mov_b64 s[82:83], s[6:7]
    s_mov_b64 exec, 0
    s_cmp_lg_u32 s92, 0
    s_cbranch_scc1 L_w_9
    s_call_b64 s[6:7], L_pad1
    s_branch L_visited_8
L_w_9:
    s_cmp_lg_u32 s92, 1
    s_cbranch_scc1 L_w_10
    s_call_b64 s[6:7], L_pad2
    s_branch L_visited_8
L_w_10:
    s_cmp_lg_u32 s92, 2
    s_cbranch_scc1 L_w_11
    s_call_b64 s[6:7], L_pad3
    s_branch L_visited_8
L_w_11:
    s_call_b64 s[6:7], L_pad4
L_visited_8:
    s_mov_b64 exec, -1
    s_mov_b64 s[6:7], s[82:83]
    s_waitcnt lgkmcnt(0)
    v_mfma_f32_16x16x32_bf16 v[128:131], v[80:83], v[64:67], v[128:131]
    ds_read_b64_tr_b16 a[176:177], v24 offset:4096
    v_mfma_f32_16x16x32_bf16 v[160:163], v[80:83], v[68:71], v[160:163]
    ds_read_b64_tr_b16 a[178:179], v24 offset:4608
    v_mfma_f32_16x16x32_bf16 v[192:195], v[80:83], v[72:75], v[192:195]
    buffer_load_dwordx4 v19, s[12:15], s47 offen offset:3072 lds
    v_mfma_f32_16x16x32_bf16 v[224:227], v[80:83], v[76:79], v[224:227]
    ds_read_b128 a[160:163], v21 offset:0
    s_add_u32 m0, s44, 49152
    v_mfma_f32_16x16x32_bf16 v[136:139], v[84:87], v[64:67], v[136:139]
    ds_read_b128 a[164:167], v21 offset:2048
    v_mfma_f32_16x16x32_bf16 v[168:171], v[84:87], v[68:71], v[168:171]
    ds_read_b128 a[168:171], v21 offset:4096
    v_mfma_f32_16x16x32_bf16 v[200:203], v[84:87], v[72:75], v[200:203]
    buffer_load_dwordx4 v8, s[8:11], s46 offen offset:0 lds
    v_mfma_f32_16x16x32_bf16 v[232:235], v[84:87], v[76:79], v[232:235]
    ds_read_b128 a[172:175], v21 offset:6144
    v_mfma_f32_16x16x32_bf16 v[132:135], v[88:91], v[64:67], v[132:135]
    ds_read_b64_tr_b16 a[180:181], v24 offset:12288
    v_mfma_f32_16x16x32_bf16 v[164:167], v[88:91], v[68:71], v[164:167]
    ds_read_b64_tr_b16 a[182:183], v24 offset:12800
    v_mfma_f32_16x16x32_bf16 v[196:199], v[88:91], v[72:75], v[196:199]
    buffer_load_dwordx4 v9, s[8:11], s46 offen offset:1024 lds
    v_mfma_f32_16x16x32_bf16 v[228:231], v[88:91], v[76:79], v[228:231]
    ds_read_b64_tr_b16 a[184:185], v25 offset:4096
    v_mfma_f32_16x16x32_bf16 v[140:143], v[92:95], v[64:67], v[140:143]
    ds_read_b64_tr_b16 a[186:187], v25 offset:4608
    v_mfma_f32_16x16x32_bf16 v[172:175], v[92:95], v[68:71], v[172:175]
    ds_read_b64_tr_b16 a[188:189], v25 offset:12288
    v_mfma_f32_16x16x32_bf16 v[204:207], v[92:95], v[72:75], v[204:207]
    buffer_load_dwordx4 v10, s[8:11], s46 offen offset:2048 lds
    v_mfma_f32_16x16x32_bf16 v[236:239], v[92:95], v[76:79], v[236:239]
    ds_read_b64_tr_b16 a[190:191], v25 offset:12800
    v_mfma_f32_16x16x32_bf16 v[144:147], v[96:99], v[64:67], v[144:147]
    ds_read_b64_tr_b16 a[192:193], v26 offset:4096
    v_mfma_f32_16x16x32_bf16 v[176:179], v[96:99], v[68:71], v[176:179]
    ds_read_b64_tr_b16 a[194:195], v26 offset:4608
    v_mfma_f32_16x16x32_bf16 v[208:211], v[96:99], v[72:75], v[208:211]
    buffer_load_dwordx4 v11, s[8:11], s46 offen offset:3072 lds
    v_mfma_f32_16x16x32_bf16 v[240:243], v[96:99], v[76:79], v[240:243]
    ds_read_b64_tr_b16 a[196:197], v26 offset:12288
    s_add_u32 m0, s44, 53248
    v_mfma_f32_16x16x32_bf16 v[152:155], v[100:103], v[64:67], v[152:155]
    ds_read_b64_tr_b16 a[198:199], v26 offset:12800
    v_mfma_f32_16x16x32_bf16 v[184:187], v[100:103], v[68:71], v[184:187]
    ds_read_b64_tr_b16 a[200:201], v27 offset:4096
    v_mfma_f32_16x16x32_bf16 v[216:219], v[100:103], v[72:75], v[216:219]
    buffer_load_dwordx4 v12, s[8:11], s46 offen offset:0 lds
    v_mfma_f32_16x16x32_bf16 v[248:251], v[100:103], v[76:79], v[248:251]
    ds_read_b64_tr_b16 a[202:203], v27 offset:4608
    v_mfma_f32_16x16x32_bf16 v[148:151], v[104:107], v[64:67], v[148:151]
    ds_read_b64_tr_b16 a[204:205], v27 offset:12288
    v_mfma_f32_16x16x32_bf16 v[180:183], v[104:107], v[68:71], v[180:183]
    ds_read_b64_tr_b16 a[206:207], v27 offset:12800
    v_mfma_f32_16x16x32_bf16 v[212:215], v[104:107], v[72:75], v[212:215]
    buffer_load_dwordx4 v13, s[8:11], s46 offen offset:1024 lds
    v_mfma_f32_16x16x32_bf16 v[244:247], v[104:107], v[76:79], v[244:247]
    v_mfma_f32_16x16x32_bf16 v[156:159], v[108:111], v[64:67], v[156:159]
    v_mfma_f32_16x16x32_bf16 v[188:191], v[108:111], v[68:71], v[188:191]
    buffer_load_dwordx4 v14, s[8:11], s46 offen offset:2048 lds
    v_mfma_f32_16x16x32_bf16 v[220:223], v[108:111], v[72:75], v[220:223]
    v_mfma_f32_16x16x32_bf16 v[252:255], v[108:111], v[76:79], v[252:255]
    s_waitcnt vmcnt(11) lgkmcnt(0)
    s_barrier
    v_mfma_f32_16x16x32_bf16 v[128:131], a[176:179], a[160:163], v[128:131]
    ds_read_b64_tr_b16 v[80:81], v28 offset:0
    s_and_b32 s83, s2, 1
    s_xor_b32 s73, s72, 0x200
    s_mul_i32 s4, s92, 14336
    s_mul_i32 s74, s7, 114688
    s_add_u32 s74, s74, s4
    s_add_u32 s75, s74, 57344
    s_lshl_b32 s4, s92, 3
    v_add_u32 v41, s4, v6
    v_add_lshl_u32 v114, s4, v41, 3
    v_lshlrev_b32 v42, 4, v7
    v_lshl_add_u32 v113, v41, 10, v42
    v_mul_u32_u24 v112, 4224, v6
    v_add_u32 v112, v112, v42
    s_lshl_b32 s4, s87, 2
    s_add_u32 s4, s4, s92
    s_mul_i32 s68, s4, 67584
    s_lshl_b32 s7, s86, 7
    s_add_u32 s68, s68, s7
    s_add_u32 s68, s68, 13631488
    s_lshl_b32 s58, s92, 7
    s_lshl_b32 s7, s7, 2
    s_add_u32 s58, s58, s7
    s_add_u32 s58, s58, 16252928
    s_lshl_b32 s4, s4, 7
    s_lshr_b32 s7, s86, 4
    s_lshl_b32 s7, s7, 12
    s_add_u32 s4, s4, s7
    s_add_u32 s59, s4, 16384000
    s_mul_i32 s69, s92, 2080
    s_add_u32 s69, s69, 147456
    v_mul_u32_u24 v42, 1040, v7
    v_and_b32 v40, 6, v6
    v_add_u32 v42, v42, v40
    v_and_b32 v40, 1, v6
    v_lshl_add_u32 v42, v40, 3, v42
    s_lshl_b32 s4, s92, 4
    v_add_u32 v42, s4, v42
    s_lshl_b32 s6, s6, 6
    s_add_u32 s4, s6, 147456
    v_add_u32 v115, s4, v42
    s_sub_u32 s4, 147520, s6
    v_add_u32 v116, s4, v42
    v_lshrrev_b32 v42, 4, v1
    v_xor_b32 v42, v42, v7
    v_lshlrev_b32 v42, 4, v42
    v_and_b32 v40, 15, v1
    v_lshl_add_u32 v42, v40, 8, v42
    v_add_u32 v117, s61, v42
    v_xor_b32 v118, 64, v117
    v_lshlrev_b32 v42, 1, v7
    v_xor_b32 v42, v42, v6
    v_lshlrev_b32 v42, 4, v42
    v_lshl_add_u32 v121, v41, 8, v42
    v_add_u32 v121, 0, v121
    v_xor_b32 v122, 16, v121
    v_mfma_f32_16x16x32_bf16 v[160:163], a[176:179], a[164:167], v[160:163]
    ds_read_b64_tr_b16 v[82:83], v28 offset:512
    buffer_load_dwordx4 v15, s[8:11], s46 offen offset:3072 lds
    v_mfma_f32_16x16x32_bf16 v[192:195], a[176:179], a[168:171], v[192:195]
    ds_read_b128 v[64:67], v22 offset:0
    s_lshl_b32 s83, s83, 7
    v_mfma_f32_16x16x32_bf16 v[224:227], a[176:179], a[172:175], v[224:227]
    ds_read_b128 v[68:71], v22 offset:2048
    s_bfe_u32 s46, s42, 196624
    v_mfma_f32_16x16x32_bf16 v[136:139], a[180:183], a[160:163], v[136:139]
    ds_read_b128 v[72:75], v22 offset:4096
    s_mov_b32 s79, 1
    v_mfma_f32_16x16x32_bf16 v[168:171], a[180:183], a[164:167], v[168:171]
    s_lshl_b32 s46, s46, 7
    s_mov_b32 m0, s88
    v_mfma_f32_16x16x32_bf16 v[200:203], a[180:183], a[168:171], v[200:203]
    buffer_load_dwordx4 v48, s[20:23], s62 offen offset:0 lds
    ds_read_b128 v[76:79], v22 offset:6144
    v_mfma_f32_16x16x32_bf16 v[232:235], a[180:183], a[172:175], v[232:235]
    ds_read_b64_tr_b16 v[84:85], v28 offset:8192
    v_mfma_f32_16x16x32_bf16 v[132:135], a[184:187], a[160:163], v[132:135]
    buffer_load_dwordx4 v49, s[20:23], s62 offen offset:1024 lds
    ds_read_b64_tr_b16 v[86:87], v28 offset:8704
    v_mfma_f32_16x16x32_bf16 v[164:167], a[184:187], a[164:167], v[164:167]
    ds_read_b64_tr_b16 v[88:89], v29 offset:0
    v_mfma_f32_16x16x32_bf16 v[196:199], a[184:187], a[168:171], v[196:199]
    s_cmp_lg_u32 s92, 0
    s_cbranch_scc1 L_sig_13
    s_atomic_add s79, s[32:33], s83
L_sig_13:
    v_mfma_f32_16x16x32_bf16 v[228:231], a[184:187], a[172:175], v[228:231]
    ds_read_b64_tr_b16 v[90:91], v29 offset:512
    v_mfma_f32_16x16x32_bf16 v[140:143], a[188:191], a[160:163], v[140:143]
    buffer_load_dwordx4 v50, s[20:23], s62 offen offset:2048 lds
    ds_read_b64_tr_b16 v[92:93], v29 offset:8192
    v_mfma_f32_16x16x32_bf16 v[172:175], a[188:191], a[164:167], v[172:175]
    ds_read_b64_tr_b16 v[94:95], v29 offset:8704
    v_mfma_f32_16x16x32_bf16 v[204:207], a[188:191], a[168:171], v[204:207]
    ds_read_b64_tr_b16 v[96:97], v30 offset:0
    v_mfma_f32_16x16x32_bf16 v[236:239], a[188:191], a[172:175], v[236:239]
    buffer_load_dwordx4 v51, s[20:23], s62 offen offset:3072 lds
    s_lshr_b32 s62, s62, 5
    v_mfma_f32_16x16x32_bf16 v[144:147], a[192:195], a[160:163], v[144:147]
    ds_read_b64_tr_b16 v[98:99], v30 offset:512
    v_lshrrev_b32 v47, 2, v1
    v_mfma_f32_16x16x32_bf16 v[176:179], a[192:195], a[164:167], v[176:179]
    ds_read_b64_tr_b16 v[100:101], v30 offset:8192
    v_lshlrev_b32 v47, 7, v47
    v_mfma_f32_16x16x32_bf16 v[208:211], a[192:195], a[168:171], v[208:211]
    ds_read_b64_tr_b16 v[102:103], v30 offset:8704
    buffer_load_dword v47, v47, s[24:27], s66 offen
    v_mfma_f32_16x16x32_bf16 v[240:243], a[192:195], a[172:175], v[240:243]
    ds_read_b64_tr_b16 v[104:105], v31 offset:0
    v_mfma_f32_16x16x32_bf16 v[152:155], a[196:199], a[160:163], v[152:155]
    v_mfma_f32_16x16x32_bf16 v[184:187], a[196:199], a[164:167], v[184:187]
    ds_read_b64_tr_b16 v[106:107], v31 offset:512
    v_mfma_f32_16x16x32_bf16 v[216:219], a[196:199], a[168:171], v[216:219]
    ds_read_b64_tr_b16 v[108:109], v31 offset:8192
    global_load_ushort v63, v63, s[98:99]
    v_mfma_f32_16x16x32_bf16 v[248:251], a[196:199], a[172:175], v[248:251]
    ds_read_b64_tr_b16 v[110:111], v31 offset:8704
    v_mfma_f32_16x16x32_bf16 v[148:151], a[200:203], a[160:163], v[148:151]
    ds_read_b32 v0, v61
    v_mfma_f32_16x16x32_bf16 v[180:183], a[200:203], a[164:167], v[180:183]
    buffer_load_ushort v36, v36, s[24:27], 0 offen
    v_mfma_f32_16x16x32_bf16 v[212:215], a[200:203], a[168:171], v[212:215]
    s_add_u32 m0, s45, 98304
    v_mfma_f32_16x16x32_bf16 v[244:247], a[200:203], a[172:175], v[244:247]
    v_mfma_f32_16x16x32_bf16 v[156:159], a[204:207], a[160:163], v[156:159]
    s_mul_i32 s47, s46, 1792
    v_mfma_f32_16x16x32_bf16 v[188:191], a[204:207], a[164:167], v[188:191]
    buffer_load_dwordx4 v16, s[12:15], s47 offen offset:0 lds
    v_mfma_f32_16x16x32_bf16 v[220:223], a[204:207], a[168:171], v[220:223]
    v_mfma_f32_16x16x32_bf16 v[252:255], a[204:207], a[172:175], v[252:255]
    s_waitcnt lgkmcnt(1)
    v_mfma_f32_16x16x32_bf16 v[128:131], v[80:83], v[64:67], v[128:131]
    ds_read_b64_tr_b16 a[176:177], v28 offset:4096
    v_mfma_f32_16x16x32_bf16 v[160:163], v[80:83], v[68:71], v[160:163]
    ds_read_b64_tr_b16 a[178:179], v28 offset:4608
    buffer_load_dwordx4 v17, s[12:15], s47 offen offset:1024 lds
    v_mfma_f32_16x16x32_bf16 v[192:195], v[80:83], v[72:75], v[192:195]
    ds_read_b128 a[160:163], v23 offset:0
    v_mfma_f32_16x16x32_bf16 v[224:227], v[80:83], v[76:79], v[224:227]
    ds_read_b128 a[164:167], v23 offset:2048
    v_mfma_f32_16x16x32_bf16 v[136:139], v[84:87], v[64:67], v[136:139]
    ds_read_b128 a[168:171], v23 offset:4096
    v_mfma_f32_16x16x32_bf16 v[168:171], v[84:87], v[68:71], v[168:171]
    buffer_load_dwordx4 v18, s[12:15], s47 offen offset:2048 lds
    v_mfma_f32_16x16x32_bf16 v[200:203], v[84:87], v[72:75], v[200:203]
    ds_read_b128 a[172:175], v23 offset:6144
    v_mfma_f32_16x16x32_bf16 v[232:235], v[84:87], v[76:79], v[232:235]
    ds_read_b64_tr_b16 a[180:181], v28 offset:12288
    v_mfma_f32_16x16x32_bf16 v[132:135], v[88:91], v[64:67], v[132:135]
    ds_read_b64_tr_b16 a[182:183], v28 offset:12800
    v_mfma_f32_16x16x32_bf16 v[164:167], v[88:91], v[68:71], v[164:167]
    buffer_load_dwordx4 v19, s[12:15], s47 offen offset:3072 lds
    ds_read_b64_tr_b16 a[184:185], v29 offset:4096
    v_mfma_f32_16x16x32_bf16 v[196:199], v[88:91], v[72:75], v[196:199]
    v_mfma_f32_16x16x32_bf16 v[228:231], v[88:91], v[76:79], v[228:231]
    ds_read_b64_tr_b16 a[186:187], v29 offset:4608
    s_add_u32 m0, s44, 98304
    v_mfma_f32_16x16x32_bf16 v[140:143], v[92:95], v[64:67], v[140:143]
    ds_read_b64_tr_b16 a[188:189], v29 offset:12288
    v_mfma_f32_16x16x32_bf16 v[172:175], v[92:95], v[68:71], v[172:175]
    buffer_load_dwordx4 v8, s[8:11], s46 offen offset:0 lds
    ds_read_b64_tr_b16 a[190:191], v29 offset:12800
    v_mfma_f32_16x16x32_bf16 v[204:207], v[92:95], v[72:75], v[204:207]
    ds_read_b64_tr_b16 a[192:193], v30 offset:4096
    v_mfma_f32_16x16x32_bf16 v[236:239], v[92:95], v[76:79], v[236:239]
    v_mfma_f32_16x16x32_bf16 v[144:147], v[96:99], v[64:67], v[144:147]
    ds_read_b64_tr_b16 a[194:195], v30 offset:4608
    v_mfma_f32_16x16x32_bf16 v[176:179], v[96:99], v[68:71], v[176:179]
    ds_read_b64_tr_b16 a[196:197], v30 offset:12288
    buffer_load_dwordx4 v9, s[8:11], s46 offen offset:1024 lds
    v_mfma_f32_16x16x32_bf16 v[208:211], v[96:99], v[72:75], v[208:211]
    ds_read_b64_tr_b16 a[198:199], v30 offset:12800
    v_mfma_f32_16x16x32_bf16 v[240:243], v[96:99], v[76:79], v[240:243]
    ds_read_b64_tr_b16 a[200:201], v31 offset:4096
    v_mfma_f32_16x16x32_bf16 v[152:155], v[100:103], v[64:67], v[152:155]
    v_mfma_f32_16x16x32_bf16 v[184:187], v[100:103], v[68:71], v[184:187]
    ds_read_b64_tr_b16 a[202:203], v31 offset:4608
    buffer_load_dwordx4 v10, s[8:11], s46 offen offset:2048 lds
    v_mfma_f32_16x16x32_bf16 v[216:219], v[100:103], v[72:75], v[216:219]
    ds_read_b64_tr_b16 a[204:205], v31 offset:12288
    s_waitcnt vmcnt(10)
    v_mfma_f32_16x16x32_bf16 v[248:251], v[100:103], v[76:79], v[248:251]
    ds_read_b64_tr_b16 a[206:207], v31 offset:12800
    ds_read_b64_tr_b16 a[0:1], v43 offset:0
    v_mfma_f32_16x16x32_bf16 v[148:151], v[104:107], v[64:67], v[148:151]
    ds_read_b64_tr_b16 a[2:3], v43 offset:2048
    ds_read_b32 v0, v61
    v_mfma_f32_16x16x32_bf16 v[180:183], v[104:107], v[68:71], v[180:183]
    buffer_load_dwordx4 v11, s[8:11], s46 offen offset:3072 lds
    v_mfma_f32_16x16x32_bf16 v[212:215], v[104:107], v[72:75], v[212:215]
    s_add_u32 m0, s44, 102400
    v_mfma_f32_16x16x32_bf16 v[244:247], v[104:107], v[76:79], v[244:247]
    ds_read_b64_tr_b16 a[4:5], v44 offset:0
    v_mfma_f32_16x16x32_bf16 v[156:159], v[108:111], v[64:67], v[156:159]
    ds_read_b64_tr_b16 a[6:7], v44 offset:2048
    v_mfma_f32_16x16x32_bf16 v[188:191], v[108:111], v[68:71], v[188:191]
    buffer_load_dwordx4 v12, s[8:11], s46 offen offset:0 lds
    v_mfma_f32_16x16x32_bf16 v[220:223], v[108:111], v[72:75], v[220:223]
    v_mfma_f32_16x16x32_bf16 v[252:255], v[108:111], v[76:79], v[252:255]
    s_waitcnt vmcnt(16) lgkmcnt(5)
    s_barrier
    v_mfma_f32_16x16x32_bf16 v[128:131], a[176:179], a[160:163], v[128:131]
    ds_read_b64_tr_b16 v[80:81], v28 offset:49152
    ds_read_b64_tr_b16 a[8:9], v45 offset:0
    v_mfma_f32_16x16x32_bf16 v[160:163], a[176:179], a[164:167], v[160:163]
    ds_read_b64_tr_b16 a[10:11], v45 offset:2048
    ds_read_b64_tr_b16 v[82:83], v28 offset:49664
    v_mfma_f32_16x16x32_bf16 v[192:195], a[176:179], a[168:171], v[192:195]
    buffer_load_dwordx4 v13, s[8:11], s46 offen offset:1024 lds
    ds_read_b128 v[64:67], v22 offset:49152
    v_mfma_f32_16x16x32_bf16 v[224:227], a[176:179], a[172:175], v[224:227]
    ds_read_b64_tr_b16 a[12:13], v46 offset:0
    ds_read_b128 v[68:71], v22 offset:51200
    v_mfma_f32_16x16x32_bf16 v[136:139], a[180:183], a[160:163], v[136:139]
    ds_read_b128 v[72:75], v22 offset:53248
    v_mfma_f32_16x16x32_bf16 v[168:171], a[180:183], a[164:167], v[168:171]
    ds_read_b64_tr_b16 a[14:15], v46 offset:2048
    v_mfma_f32_16x16x32_bf16 v[200:203], a[180:183], a[168:171], v[200:203]
    ds_read_b128 v[76:79], v22 offset:55296
    buffer_load_dwordx4 v14, s[8:11], s46 offen offset:2048 lds
    v_mfma_f32_16x16x32_bf16 v[232:235], a[180:183], a[172:175], v[232:235]
    ds_read_b64_tr_b16 v[84:85], v28 offset:57344
    v_mfma_f32_16x16x32_bf16 v[132:135], a[184:187], a[160:163], v[132:135]
    ds_read_b64_tr_b16 v[86:87], v28 offset:57856
    v_mfma_f32_16x16x32_bf16 v[164:167], a[184:187], a[164:167], v[164:167]
    ds_read_b64_tr_b16 v[88:89], v29 offset:49152
    v_mfma_f32_16x16x32_bf16 v[196:199], a[184:187], a[168:171], v[196:199]
    v_mfma_f32_16x16x32_bf16 v[228:231], a[184:187], a[172:175], v[228:231]
    buffer_load_dwordx4 v15, s[8:11], s46 offen offset:3072 lds
    ds_read_b64_tr_b16 v[90:91], v29 offset:49664
    v_mfma_f32_16x16x32_bf16 v[140:143], a[188:191], a[160:163], v[140:143]
    ds_read_b64_tr_b16 v[92:93], v29 offset:57344
    s_bfe_u32 s46, s42, 196628
    v_mfma_f32_16x16x32_bf16 v[172:175], a[188:191], a[164:167], v[172:175]
    ds_read_b64_tr_b16 v[94:95], v29 offset:57856
    s_lshl_b32 s46, s46, 7
    v_mfma_f32_16x16x32_bf16 v[204:207], a[188:191], a[168:171], v[204:207]
    ds_read_b64_tr_b16 v[96:97], v30 offset:49152
    s_waitcnt lgkmcnt(8)
    v_mfma_f32_16x16x32_bf16 v[236:239], a[188:191], a[172:175], v[236:239]
    s_mov_b32 m0, s88
    v_mfma_f32_16x16x32_bf16 v[144:147], a[192:195], a[160:163], v[144:147]
    buffer_load_dwordx4 v48, s[20:23], s0 offen offset:0 lds
    ds_read_b64_tr_b16 v[98:99], v30 offset:49664
    v_mfma_f32_16x16x32_bf16 v[176:179], a[192:195], a[164:167], v[176:179]
    ds_read_b64_tr_b16 v[100:101], v30 offset:57344
    v_mfma_f32_16x16x32_bf16 v[208:211], a[192:195], a[168:171], v[208:211]
    ds_read_b64_tr_b16 v[102:103], v30 offset:57856
    v_mfma_f32_16x16x32_bf16 v[240:243], a[192:195], a[172:175], v[240:243]
    ds_read_b64_tr_b16 v[104:105], v31 offset:49152
    buffer_load_dwordx4 v49, s[20:23], s0 offen offset:1024 lds
    v_mfma_f32_16x16x32_bf16 v[152:155], a[196:199], a[160:163], v[152:155]
    v_mfma_f32_16x16x32_bf16 v[184:187], a[196:199], a[164:167], v[184:187]
    ds_read_b64_tr_b16 v[106:107], v31 offset:49664
    v_mfma_f32_16x16x32_bf16 v[216:219], a[196:199], a[168:171], v[216:219]
    ds_read_b64_tr_b16 v[108:109], v31 offset:57344
    v_mfma_f32_16x16x32_bf16 v[248:251], a[196:199], a[172:175], v[248:251]
    ds_read_b64_tr_b16 v[110:111], v31 offset:57856
    v_mfma_f32_16x16x32_bf16 v[148:151], a[200:203], a[160:163], v[148:151]
    buffer_load_dwordx4 v50, s[20:23], s0 offen offset:2048 lds
    ds_read_b32 v0, v61
    v_mfma_f32_16x16x32_bf16 v[180:183], a[200:203], a[164:167], v[180:183]
    v_mfma_f32_16x16x32_bf16 v[212:215], a[200:203], a[168:171], v[212:215]
    v_mfma_f32_16x16x32_bf16 v[244:247], a[200:203], a[172:175], v[244:247]
    v_mfma_f32_16x16x32_bf16 v[156:159], a[204:207], a[160:163], v[156:159]
    buffer_load_dwordx4 v51, s[20:23], s0 offen offset:3072 lds
    s_lshr_b32 s0, s0, 5
    v_mfma_f32_16x16x32_bf16 v[188:191], a[204:207], a[164:167], v[188:191]
    v_mfma_f32_16x16x32_bf16 v[220:223], a[204:207], a[168:171], v[220:223]
    v_mfma_f32_16x16x32_bf16 v[252:255], a[204:207], a[172:175], v[252:255]
    s_waitcnt lgkmcnt(1)
    v_mfma_f32_16x16x32_bf16 v[128:131], v[80:83], v[64:67], v[128:131]
    ds_read_b64_tr_b16 a[176:177], v28 offset:53248
    s_add_u32 m0, s45, 0
    v_mfma_f32_16x16x32_bf16 v[160:163], v[80:83], v[68:71], v[160:163]
L_pad1:
    s_cbranch_execz L_return
    ds_read_b64_tr_b16 a[178:179], v28 offset:53760
    s_mul_i32 s47, s46, 1792
    v_mfma_f32_16x16x32_bf16 v[192:195], v[80:83], v[72:75], v[192:195]
    buffer_load_dwordx4 v16, s[12:15], s47 offen offset:0 lds
    v_mfma_f32_16x16x32_bf16 v[224:227], v[80:83], v[76:79], v[224:227]
    ds_read_b128 a[160:163], v23 offset:49152
    v_mfma_f32_16x16x32_bf16 v[136:139], v[84:87], v[64:67], v[136:139]
    ds_read_b128 a[164:167], v23 offset:51200
    v_mfma_f32_16x16x32_bf16 v[168:171], v[84:87], v[68:71], v[168:171]
    ds_read_b128 a[168:171], v23 offset:53248
    v_mfma_f32_16x16x32_bf16 v[200:203], v[84:87], v[72:75], v[200:203]
    buffer_load_dwordx4 v17, s[12:15], s47 offen offset:1024 lds
    v_mfma_f32_16x16x32_bf16 v[232:235], v[84:87], v[76:79], v[232:235]
    ds_read_b128 a[172:175], v23 offset:55296
    v_mfma_f32_16x16x32_bf16 v[132:135], v[88:91], v[64:67], v[132:135]
    ds_read_b64_tr_b16 a[180:181], v28 offset:61440
    v_mfma_f32_16x16x32_bf16 v[164:167], v[88:91], v[68:71], v[164:167]
    ds_read_b64_tr_b16 a[182:183], v28 offset:61952
    v_mfma_f32_16x16x32_bf16 v[196:199], v[88:91], v[72:75], v[196:199]
    buffer_load_dwordx4 v18, s[12:15], s47 offen offset:2048 lds
    v_mfma_f32_16x16x32_bf16 v[228:231], v[88:91], v[76:79], v[228:231]
    ds_read_b64_tr_b16 a[184:185], v29 offset:53248
    v_mfma_f32_16x16x32_bf16 v[140:143], v[92:95], v[64:67], v[140:143]
    ds_read_b64_tr_b16 a[186:187], v29 offset:53760
    v_mfma_f32_16x16x32_bf16 v[172:175], v[92:95], v[68:71], v[172:175]
    ds_read_b64_tr_b16 a[188:189], v29 offset:61440
    v_mfma_f32_16x16x32_bf16 v[204:207], v[92:95], v[72:75], v[204:207]
    buffer_load_dwordx4 v19, s[12:15], s47 offen offset:3072 lds
    v_mfma_f32_16x16x32_bf16 v[236:239], v[92:95], v[76:79], v[236:239]
    ds_read_b64_tr_b16 a[190:191], v29 offset:61952
    s_add_u32 m0, s44, 0
    v_mfma_f32_16x16x32_bf16 v[144:147], v[96:99], v[64:67], v[144:147]
    ds_read_b64_tr_b16 a[192:193], v30 offset:53248
    v_mfma_f32_16x16x32_bf16 v[176:179], v[96:99], v[68:71], v[176:179]
    ds_read_b64_tr_b16 a[194:195], v30 offset:53760
    v_mfma_f32_16x16x32_bf16 v[208:211], v[96:99], v[72:75], v[208:211]
    ds_read_b64_tr_b16 a[196:197], v30 offset:61440
    v_mfma_f32_16x16x32_bf16 v[240:243], v[96:99], v[76:79], v[240:243]
    buffer_load_dwordx4 v8, s[8:11], s46 offen offset:0 lds
    v_mfma_f32_16x16x32_bf16 v[152:155], v[100:103], v[64:67], v[152:155]
    ds_read_b64_tr_b16 a[198:199], v30 offset:61952
    v_mfma_f32_16x16x32_bf16 v[184:187], v[100:103], v[68:71], v[184:187]
    ds_read_b64_tr_b16 a[200:201], v31 offset:53248
    v_mfma_f32_16x16x32_bf16 v[216:219], v[100:103], v[72:75], v[216:219]
    ds_read_b64_tr_b16 a[202:203], v31 offset:53760
    v_mfma_f32_16x16x32_bf16 v[248:251], v[100:103], v[76:79], v[248:251]
    buffer_load_dwordx4 v9, s[8:11], s46 offen offset:1024 lds
    v_mfma_f32_16x16x32_bf16 v[148:151], v[104:107], v[64:67], v[148:151]
    ds_read_b64_tr_b16 a[204:205], v31 offset:61440
    v_mfma_f32_16x16x32_bf16 v[180:183], v[104:107], v[68:71], v[180:183]
    ds_read_b64_tr_b16 a[206:207], v31 offset:61952
    v_mfma_f32_16x16x32_bf16 v[212:215], v[104:107], v[72:75], v[212:215]
    ds_read_b32 v0, v61
    v_mfma_f32_16x16x32_bf16 v[244:247], v[104:107], v[76:79], v[244:247]
    buffer_load_dwordx4 v10, s[8:11], s46 offen offset:2048 lds
    v_mfma_f32_16x16x32_bf16 v[156:159], v[108:111], v[64:67], v[156:159]
    v_mfma_f32_16x16x32_bf16 v[188:191], v[108:111], v[68:71], v[188:191]
    buffer_load_dwordx4 v11, s[8:11], s46 offen offset:3072 lds
    s_add_u32 m0, s44, 4096
    v_mfma_f32_16x16x32_bf16 v[220:223], v[108:111], v[72:75], v[220:223]
    v_mfma_f32_16x16x32_bf16 v[252:255], v[108:111], v[76:79], v[252:255]
    s_waitcnt vmcnt(12) lgkmcnt(1)
    s_barrier
    v_mfma_f32_16x16x32_bf16 v[128:131], a[176:179], a[160:163], v[128:131]
    ds_read_b64_tr_b16 v[80:81], v24 offset:0
    s_waitcnt vmcnt(8)
    v_mfma_f32_16x16x32_bf16 v[160:163], a[176:179], a[164:167], v[160:163]
    ds_read_b64_tr_b16 a[16:17], v43 offset:0
    ds_read_b64_tr_b16 a[18:19], v43 offset:2048
    v_mfma_f32_16x16x32_bf16 v[192:195], a[176:179], a[168:171], v[192:195]
    ds_read_b64_tr_b16 v[82:83], v24 offset:512
    buffer_load_dwordx4 v12, s[8:11], s46 offen offset:0 lds
    v_mfma_f32_16x16x32_bf16 v[224:227], a[176:179], a[172:175], v[224:227]
    ds_read_b128 v[64:67], v20 offset:0
    ds_read_b64_tr_b16 a[20:21], v44 offset:0
    v_mfma_f32_16x16x32_bf16 v[136:139], a[180:183], a[160:163], v[136:139]
    ds_read_b128 v[68:71], v20 offset:2048
    ds_read_b128 v[72:75], v20 offset:4096
    v_mfma_f32_16x16x32_bf16 v[168:171], a[180:183], a[164:167], v[168:171]
    ds_read_b64_tr_b16 a[22:23], v44 offset:2048
    v_mfma_f32_16x16x32_bf16 v[200:203], a[180:183], a[168:171], v[200:203]
    ds_read_b128 v[76:79], v20 offset:6144
    buffer_load_dwordx4 v13, s[8:11], s46 offen offset:1024 lds
    v_mfma_f32_16x16x32_bf16 v[232:235], a[180:183], a[172:175], v[232:235]
    ds_read_b64_tr_b16 v[84:85], v24 offset:8192
    v_mfma_f32_16x16x32_bf16 v[132:135], a[184:187], a[160:163], v[132:135]
    ds_read_b64_tr_b16 a[24:25], v45 offset:0
    ds_read_b64_tr_b16 v[86:87], v24 offset:8704
    v_mfma_f32_16x16x32_bf16 v[164:167], a[184:187], a[164:167], v[164:167]
    ds_read_b64_tr_b16 a[26:27], v45 offset:2048
    ds_read_b64_tr_b16 v[88:89], v25 offset:0
    v_mfma_f32_16x16x32_bf16 v[196:199], a[184:187], a[168:171], v[196:199]
    v_mfma_f32_16x16x32_bf16 v[228:231], a[184:187], a[172:175], v[228:231]
    buffer_load_dwordx4 v14, s[8:11], s46 offen offset:2048 lds
    ds_read_b64_tr_b16 v[90:91], v25 offset:512
    v_mfma_f32_16x16x32_bf16 v[140:143], a[188:191], a[160:163], v[140:143]
    ds_read_b64_tr_b16 v[92:93], v25 offset:8192
    ds_read_b64_tr_b16 a[28:29], v46 offset:0
    v_mfma_f32_16x16x32_bf16 v[172:175], a[188:191], a[164:167], v[172:175]
    ds_read_b64_tr_b16 v[94:95], v25 offset:8704
    v_mfma_f32_16x16x32_bf16 v[204:207], a[188:191], a[168:171], v[204:207]
    ds_read_b64_tr_b16 a[30:31], v46 offset:2048
    ds_read_b64_tr_b16 v[96:97], v26 offset:0
    v_mfma_f32_16x16x32_bf16 v[236:239], a[188:191], a[172:175], v[236:239]
    buffer_load_dwordx4 v15, s[8:11], s46 offen offset:3072 lds
    v_mfma_f32_16x16x32_bf16 v[144:147], a[192:195], a[160:163], v[144:147]
    ds_read_b64_tr_b16 v[98:99], v26 offset:512
    s_bfe_u32 s46, s42, 196632
    v_mfma_f32_16x16x32_bf16 v[176:179], a[192:195], a[164:167], v[176:179]
    ds_read_b64_tr_b16 v[100:101], v26 offset:8192
    s_lshl_b32 s46, s46, 7
    v_mfma_f32_16x16x32_bf16 v[208:211], a[192:195], a[168:171], v[208:211]
    ds_read_b64_tr_b16 v[102:103], v26 offset:8704
    s_waitcnt lgkmcnt(4)
    v_mfma_f32_16x16x32_bf16 v[240:243], a[192:195], a[172:175], v[240:243]
    ds_read_b64_tr_b16 v[104:105], v27 offset:0
    s_mov_b32 m0, s88
    v_mfma_f32_16x16x32_bf16 v[152:155], a[196:199], a[160:163], v[152:155]
    buffer_load_dwordx4 v48, s[20:23], s1 offen offset:0 lds
    v_mfma_f32_16x16x32_bf16 v[184:187], a[196:199], a[164:167], v[184:187]
    ds_read_b64_tr_b16 v[106:107], v27 offset:512
    v_mfma_f32_16x16x32_bf16 v[216:219], a[196:199], a[168:171], v[216:219]
    ds_read_b64_tr_b16 v[108:109], v27 offset:8192
    v_mfma_f32_16x16x32_bf16 v[248:251], a[196:199], a[172:175], v[248:251]
    ds_read_b64_tr_b16 v[110:111], v27 offset:8704
    v_mfma_f32_16x16x32_bf16 v[148:151], a[200:203], a[160:163], v[148:151]
    buffer_load_dwordx4 v49, s[20:23], s1 offen offset:1024 lds
    ds_read_b32 v0, v61
    v_mfma_f32_16x16x32_bf16 v[180:183], a[200:203], a[164:167], v[180:183]
    v_mfma_f32_16x16x32_bf16 v[212:215], a[200:203], a[168:171], v[212:215]
    v_mfma_f32_16x16x32_bf16 v[244:247], a[200:203], a[172:175], v[244:247]
    v_mfma_f32_16x16x32_bf16 v[156:159], a[204:207], a[160:163], v[156:159]
    buffer_load_dwordx4 v50, s[20:23], s1 offen offset:2048 lds
    v_mfma_f32_16x16x32_bf16 v[188:191], a[204:207], a[164:167], v[188:191]
    v_mfma_f32_16x16x32_bf16 v[220:223], a[204:207], a[168:171], v[220:223]
    v_mfma_f32_16x16x32_bf16 v[252:255], a[204:207], a[172:175], v[252:255]
    s_waitcnt lgkmcnt(1)
    v_mfma_f32_16x16x32_bf16 v[128:131], v[80:83], v[64:67], v[128:131]
    ds_read_b64_tr_b16 a[176:177], v24 offset:4096
    v_mfma_f32_16x16x32_bf16 v[160:163], v[80:83], v[68:71], v[160:163]
    ds_read_b64_tr_b16 a[178:179], v24 offset:4608
    v_mfma_f32_16x16x32_bf16 v[192:195], v[80:83], v[72:75], v[192:195]
    buffer_load_dwordx4 v51, s[20:23], s1 offen offset:3072 lds
    s_lshr_b32 s1, s1, 5
    v_mfma_f32_16x16x32_bf16 v[224:227], v[80:83], v[76:79], v[224:227]
    ds_read_b128 a[160:163], v21 offset:0
    s_add_u32 m0, s45, 49152
    v_mfma_f32_16x16x32_bf16 v[136:139], v[84:87], v[64:67], v[136:139]
    ds_read_b128 a[164:167], v21 offset:2048
    v_mfma_f32_16x16x32_bf16 v[168:171], v[84:87], v[68:71], v[168:171]
    ds_read_b128 a[168:171], v21 offset:4096
    s_mul_i32 s47, s46, 1792
    v_mfma_f32_16x16x32_bf16 v[200:203], v[84:87], v[72:75], v[200:203]
    ds_read_b128 a[172:175], v21 offset:6144
    v_mfma_f32_16x16x32_bf16 v[232:235], v[84:87], v[76:79], v[232:235]
    buffer_load_dwordx4 v16, s[12:15], s47 offen offset:0 lds
    v_mfma_f32_16x16x32_bf16 v[132:135], v[88:91], v[64:67], v[132:135]
    ds_read_b64_tr_b16 a[180:181], v24 offset:12288
    v_mfma_f32_16x16x32_bf16 v[164:167], v[88:91], v[68:71], v[164:167]
    ds_read_b64_tr_b16 a[182:183], v24 offset:12800
    v_mfma_f32_16x16x32_bf16 v[196:199], v[88:91], v[72:75], v[196:199]
    ds_read_b64_tr_b16 a[184:185], v25 offset:4096
    v_mfma_f32_16x16x32_bf16 v[228:231], v[88:91], v[76:79], v[228:231]
    buffer_load_dwordx4 v17, s[12:15], s47 offen offset:1024 lds
    v_mfma_f32_16x16x32_bf16 v[140:143], v[92:95], v[64:67], v[140:143]
    ds_read_b64_tr_b16 a[186:187], v25 offset:4608
    v_mfma_f32_16x16x32_bf16 v[172:175], v[92:95], v[68:71], v[172:175]
    ds_read_b64_tr_b16 a[188:189], v25 offset:12288
    v_mfma_f32_16x16x32_bf16 v[204:207], v[92:95], v[72:75], v[204:207]
    ds_read_b64_tr_b16 a[190:191], v25 offset:12800
    v_mfma_f32_16x16x32_bf16 v[236:239], v[92:95], v[76:79], v[236:239]
    ds_read_b64_tr_b16 a[192:193], v26 offset:4096
    v_mfma_f32_16x16x32_bf16 v[144:147], v[96:99], v[64:67], v[144:147]
    buffer_load_dwordx4 v18, s[12:15], s47 offen offset:2048 lds
    v_mfma_f32_16x16x32_bf16 v[176:179], v[96:99], v[68:71], v[176:179]
    ds_read_b64_tr_b16 a[194:195], v26 offset:4608
    v_mfma_f32_16x16x32_bf16 v[208:211], v[96:99], v[72:75], v[208:211]
    ds_read_b64_tr_b16 a[196:197], v26 offset:12288
    v_mfma_f32_16x16x32_bf16 v[240:243], v[96:99], v[76:79], v[240:243]
    ds_read_b64_tr_b16 a[198:199], v26 offset:12800
    v_mfma_f32_16x16x32_bf16 v[152:155], v[100:103], v[64:67], v[152:155]
    ds_read_b64_tr_b16 a[200:201], v27 offset:4096
    v_mfma_f32_16x16x32_bf16 v[184:187], v[100:103], v[68:71], v[184:187]
    buffer_load_dwordx4 v19, s[12:15], s47 offen offset:3072 lds
    v_mfma_f32_16x16x32_bf16 v[216:219], v[100:103], v[72:75], v[216:219]
    ds_read_b64_tr_b16 a[202:203], v27 offset:4608
    s_add_u32 m0, s44, 49152
    v_mfma_f32_16x16x32_bf16 v[248:251], v[100:103], v[76:79], v[248:251]
    ds_read_b64_tr_b16 a[204:205], v27 offset:12288
    v_mfma_f32_16x16x32_bf16 v[148:151], v[104:107], v[64:67], v[148:151]
    ds_read_b64_tr_b16 a[206:207], v27 offset:12800
    v_mfma_f32_16x16x32_bf16 v[180:183], v[104:107], v[68:71], v[180:183]
    buffer_load_dwordx4 v8, s[8:11], s46 offen offset:0 lds
    v_mfma_f32_16x16x32_bf16 v[212:215], v[104:107], v[72:75], v[212:215]
    ds_read_b32 v0, v61
    v_mfma_f32_16x16x32_bf16 v[244:247], v[104:107], v[76:79], v[244:247]
    v_mfma_f32_16x16x32_bf16 v[156:159], v[108:111], v[64:67], v[156:159]
    buffer_load_dwordx4 v9, s[8:11], s46 offen offset:1024 lds
    v_mfma_f32_16x16x32_bf16 v[188:191], v[108:111], v[68:71], v[188:191]
    v_mfma_f32_16x16x32_bf16 v[220:223], v[108:111], v[72:75], v[220:223]
    v_mfma_f32_16x16x32_bf16 v[252:255], v[108:111], v[76:79], v[252:255]
    s_waitcnt vmcnt(10) lgkmcnt(1)
    s_barrier
    v_mfma_f32_16x16x32_bf16 v[128:131], a[176:179], a[160:163], v[128:131]
    ds_read_b64_tr_b16 v[80:81], v28 offset:0
    v_mfma_f32_16x16x32_bf16 v[160:163], a[176:179], a[164:167], v[160:163]
    ds_read_b64_tr_b16 v[82:83], v28 offset:512
    v_mfma_f32_16x16x32_bf16 v[192:195], a[176:179], a[168:171], v[192:195]
    buffer_load_dwordx4 v10, s[8:11], s46 offen offset:2048 lds
    ds_read_b128 v[64:67], v22 offset:0
    v_mfma_f32_16x16x32_bf16 v[224:227], a[176:179], a[172:175], v[224:227]
    ds_read_b128 v[68:71], v22 offset:2048
    v_mfma_f32_16x16x32_bf16 v[136:139], a[180:183], a[160:163], v[136:139]
    ds_read_b128 v[72:75], v22 offset:4096
    v_mfma_f32_16x16x32_bf16 v[168:171], a[180:183], a[164:167], v[168:171]
    v_mfma_f32_16x16x32_bf16 v[200:203], a[180:183], a[168:171], v[200:203]
    ds_read_b128 v[76:79], v22 offset:6144
    buffer_load_dwordx4 v11, s[8:11], s46 offen offset:3072 lds
    v_mfma_f32_16x16x32_bf16 v[232:235], a[180:183], a[172:175], v[232:235]
    ds_read_b64_tr_b16 v[84:85], v28 offset:8192
    s_add_u32 m0, s44, 53248
    v_mfma_f32_16x16x32_bf16 v[132:135], a[184:187], a[160:163], v[132:135]
    ds_read_b64_tr_b16 v[86:87], v28 offset:8704
    s_waitcnt vmcnt(8)
    v_mfma_f32_16x16x32_bf16 v[164:167], a[184:187], a[164:167], v[164:167]
    ds_read_b64_tr_b16 a[32:33], v43 offset:0
    ds_read_b64_tr_b16 v[88:89], v29 offset:0
    v_mfma_f32_16x16x32_bf16 v[196:199], a[184:187], a[168:171], v[196:199]
    ds_read_b64_tr_b16 a[34:35], v43 offset:2048
    v_mfma_f32_16x16x32_bf16 v[228:231], a[184:187], a[172:175], v[228:231]
    buffer_load_dwordx4 v12, s[8:11], s46 offen offset:0 lds
    ds_read_b64_tr_b16 v[90:91], v29 offset:512
    v_mfma_f32_16x16x32_bf16 v[140:143], a[188:191], a[160:163], v[140:143]
    ds_read_b64_tr_b16 v[92:93], v29 offset:8192
    ds_read_b64_tr_b16 a[36:37], v44 offset:0
    v_mfma_f32_16x16x32_bf16 v[172:175], a[188:191], a[164:167], v[172:175]
    ds_read_b64_tr_b16 v[94:95], v29 offset:8704
    v_mfma_f32_16x16x32_bf16 v[204:207], a[188:191], a[168:171], v[204:207]
    ds_read_b64_tr_b16 a[38:39], v44 offset:2048
    ds_read_b64_tr_b16 v[96:97], v30 offset:0
    v_mfma_f32_16x16x32_bf16 v[236:239], a[188:191], a[172:175], v[236:239]
    buffer_load_dwordx4 v13, s[8:11], s46 offen offset:1024 lds
    v_mfma_f32_16x16x32_bf16 v[144:147], a[192:195], a[160:163], v[144:147]
    ds_read_b64_tr_b16 v[98:99], v30 offset:512
    ds_read_b64_tr_b16 a[40:41], v45 offset:0
    v_mfma_f32_16x16x32_bf16 v[176:179], a[192:195], a[164:167], v[176:179]
    ds_read_b64_tr_b16 v[100:101], v30 offset:8192
    v_mfma_f32_16x16x32_bf16 v[208:211], a[192:195], a[168:171], v[208:211]
    ds_read_b64_tr_b16 a[42:43], v45 offset:2048
    ds_read_b64_tr_b16 v[102:103], v30 offset:8704
    v_mfma_f32_16x16x32_bf16 v[240:243], a[192:195], a[172:175], v[240:243]
    ds_read_b64_tr_b16 v[104:105], v31 offset:0
    buffer_load_dwordx4 v14, s[8:11], s46 offen offset:2048 lds
    v_mfma_f32_16x16x32_bf16 v[152:155], a[196:199], a[160:163], v[152:155]
    v_mfma_f32_16x16x32_bf16 v[184:187], a[196:199], a[164:167], v[184:187]
    ds_read_b64_tr_b16 v[106:107], v31 offset:512
    ds_read_b64_tr_b16 a[44:45], v46 offset:0
    v_mfma_f32_16x16x32_bf16 v[216:219], a[196:199], a[168:171], v[216:219]
    ds_read_b64_tr_b16 v[108:109], v31 offset:8192
    ds_read_b64_tr_b16 a[46:47], v46 offset:2048
    v_mfma_f32_16x16x32_bf16 v[248:251], a[196:199], a[172:175], v[248:251]
    ds_read_b64_tr_b16 v[110:111], v31 offset:8704
    v_mfma_f32_16x16x32_bf16 v[148:151], a[200:203], a[160:163], v[148:151]
    buffer_load_dwordx4 v15, s[8:11], s46 offen offset:3072 lds
    ds_read_b32 v0, v61
    v_mfma_f32_16x16x32_bf16 v[180:183], a[200:203], a[164:167], v[180:183]
    s_bfe_u32 s46, s42, 196636
    v_mfma_f32_16x16x32_bf16 v[212:215], a[200:203], a[168:171], v[212:215]
    s_lshl_b32 s46, s46, 7
    v_mfma_f32_16x16x32_bf16 v[244:247], a[200:203], a[172:175], v[244:247]
    s_add_u32 m0, s45, 98304
    s_mul_i32 s47, s46, 1792
    v_mfma_f32_16x16x32_bf16 v[156:159], a[204:207], a[160:163], v[156:159]
    buffer_load_dwordx4 v16, s[12:15], s47 offen offset:0 lds
    v_mfma_f32_16x16x32_bf16 v[188:191], a[204:207], a[164:167], v[188:191]
    v_mfma_f32_16x16x32_bf16 v[220:223], a[204:207], a[168:171], v[220:223]
    v_mfma_f32_16x16x32_bf16 v[252:255], a[204:207], a[172:175], v[252:255]
    s_waitcnt lgkmcnt(1)
    v_mfma_f32_16x16x32_bf16 v[128:131], v[80:83], v[64:67], v[128:131]
    ds_read_b64_tr_b16 a[176:177], v28 offset:4096
    v_mfma_f32_16x16x32_bf16 v[160:163], v[80:83], v[68:71], v[160:163]
    ds_read_b64_tr_b16 a[178:179], v28 offset:4608
    v_mfma_f32_16x16x32_bf16 v[192:195], v[80:83], v[72:75], v[192:195]
    buffer_load_dwordx4 v17, s[12:15], s47 offen offset:1024 lds
    v_mfma_f32_16x16x32_bf16 v[224:227], v[80:83], v[76:79], v[224:227]
    ds_read_b128 a[160:163], v23 offset:0
    v_mfma_f32_16x16x32_bf16 v[136:139], v[84:87], v[64:67], v[136:139]
    ds_read_b128 a[164:167], v23 offset:2048
    v_mfma_f32_16x16x32_bf16 v[168:171], v[84:87], v[68:71], v[168:171]
    ds_read_b128 a[168:171], v23 offset:4096
    v_mfma_f32_16x16x32_bf16 v[200:203], v[84:87], v[72:75], v[200:203]
    ds_read_b128 a[172:175], v23 offset:6144
    v_mfma_f32_16x16x32_bf16 v[232:235], v[84:87], v[76:79], v[232:235]
    buffer_load_dwordx4 v18, s[12:15], s47 offen offset:2048 lds
    v_mfma_f32_16x16x32_bf16 v[132:135], v[88:91], v[64:67], v[132:135]
    ds_read_b64_tr_b16 a[180:181], v28 offset:12288
    v_mfma_f32_16x16x32_bf16 v[164:167], v[88:91], v[68:71], v[164:167]
    ds_read_b64_tr_b16 a[182:183], v28 offset:12800
    v_mfma_f32_16x16x32_bf16 v[196:199], v[88:91], v[72:75], v[196:199]
    ds_read_b64_tr_b16 a[184:185], v29 offset:4096
    v_mfma_f32_16x16x32_bf16 v[228:231], v[88:91], v[76:79], v[228:231]
    buffer_load_dwordx4 v19, s[12:15], s47 offen offset:3072 lds
    v_mfma_f32_16x16x32_bf16 v[140:143], v[92:95], v[64:67], v[140:143]
    ds_read_b64_tr_b16 a[186:187], v29 offset:4608
    v_mfma_f32_16x16x32_bf16 v[172:175], v[92:95], v[68:71], v[172:175]
    ds_read_b64_tr_b16 a[188:189], v29 offset:12288
    s_add_u32 m0, s44, 98304
    v_mfma_f32_16x16x32_bf16 v[204:207], v[92:95], v[72:75], v[204:207]
    ds_read_b64_tr_b16 a[190:191], v29 offset:12800
    v_mfma_f32_16x16x32_bf16 v[236:239], v[92:95], v[76:79], v[236:239]
    buffer_load_dwordx4 v8, s[8:11], s46 offen offset:0 lds
    v_mfma_f32_16x16x32_bf16 v[144:147], v[96:99], v[64:67], v[144:147]
    ds_read_b64_tr_b16 a[192:193], v30 offset:4096
    v_mfma_f32_16x16x32_bf16 v[176:179], v[96:99], v[68:71], v[176:179]
    ds_read_b64_tr_b16 a[194:195], v30 offset:4608
    v_mfma_f32_16x16x32_bf16 v[208:211], v[96:99], v[72:75], v[208:211]
    ds_read_b64_tr_b16 a[196:197], v30 offset:12288
    v_mfma_f32_16x16x32_bf16 v[240:243], v[96:99], v[76:79], v[240:243]
    ds_read_b64_tr_b16 a[198:199], v30 offset:12800
    v_mfma_f32_16x16x32_bf16 v[152:155], v[100:103], v[64:67], v[152:155]
    buffer_load_dwordx4 v9, s[8:11], s46 offen offset:1024 lds
    v_mfma_f32_16x16x32_bf16 v[184:187], v[100:103], v[68:71], v[184:187]
    ds_read_b64_tr_b16 a[200:201], v31 offset:4096
    v_mfma_f32_16x16x32_bf16 v[216:219], v[100:103], v[72:75], v[216:219]
    ds_read_b64_tr_b16 a[202:203], v31 offset:4608
    v_mfma_f32_16x16x32_bf16 v[248:251], v[100:103], v[76:79], v[248:251]
    ds_read_b64_tr_b16 a[204:205], v31 offset:12288
    v_mfma_f32_16x16x32_bf16 v[148:151], v[104:107], v[64:67], v[148:151]
    buffer_load_dwordx4 v10, s[8:11], s46 offen offset:2048 lds
    v_mfma_f32_16x16x32_bf16 v[180:183], v[104:107], v[68:71], v[180:183]
    ds_read_b64_tr_b16 a[206:207], v31 offset:12800
    v_mfma_f32_16x16x32_bf16 v[212:215], v[104:107], v[72:75], v[212:215]
    v_mfma_f32_16x16x32_bf16 v[244:247], v[104:107], v[76:79], v[244:247]
    v_mfma_f32_16x16x32_bf16 v[156:159], v[108:111], v[64:67], v[156:159]
    buffer_load_dwordx4 v11, s[8:11], s46 offen offset:3072 lds
    s_add_u32 m0, s44, 102400
    v_mfma_f32_16x16x32_bf16 v[188:191], v[108:111], v[68:71], v[188:191]
    v_mfma_f32_16x16x32_bf16 v[220:223], v[108:111], v[72:75], v[220:223]
    v_mfma_f32_16x16x32_bf16 v[252:255], v[108:111], v[76:79], v[252:255]
    s_waitcnt vmcnt(8) lgkmcnt(0)
    s_barrier
    v_mfma_f32_16x16x32_bf16 v[128:131], a[176:179], a[160:163], v[128:131]
    ds_read_b64_tr_b16 v[80:81], v28 offset:49152
    v_mfma_f32_16x16x32_bf16 v[160:163], a[176:179], a[164:167], v[160:163]
    ds_read_b64_tr_b16 v[82:83], v28 offset:49664
    v_mfma_f32_16x16x32_bf16 v[192:195], a[176:179], a[168:171], v[192:195]
    buffer_load_dwordx4 v12, s[8:11], s46 offen offset:0 lds
    v_mfma_f32_16x16x32_bf16 v[224:227], a[176:179], a[172:175], v[224:227]
    ds_read_b128 v[64:67], v22 offset:49152
    v_mfma_f32_16x16x32_bf16 v[136:139], a[180:183], a[160:163], v[136:139]
    ds_read_b128 v[68:71], v22 offset:51200
    v_mfma_f32_16x16x32_bf16 v[168:171], a[180:183], a[164:167], v[168:171]
    ds_read_b128 v[72:75], v22 offset:53248
    v_mfma_f32_16x16x32_bf16 v[200:203], a[180:183], a[168:171], v[200:203]
    ds_read_b128 v[76:79], v22 offset:55296
    v_mfma_f32_16x16x32_bf16 v[232:235], a[180:183], a[172:175], v[232:235]
    buffer_load_dwordx4 v13, s[8:11], s46 offen offset:1024 lds
    v_mfma_f32_16x16x32_bf16 v[132:135], a[184:187], a[160:163], v[132:135]
    ds_read_b64_tr_b16 v[84:85], v28 offset:57344
    v_mfma_f32_16x16x32_bf16 v[164:167], a[184:187], a[164:167], v[164:167]
    ds_read_b64_tr_b16 v[86:87], v28 offset:57856
    v_mfma_f32_16x16x32_bf16 v[196:199], a[184:187], a[168:171], v[196:199]
    ds_read_b64_tr_b16 v[88:89], v29 offset:49152
    v_mfma_f32_16x16x32_bf16 v[228:231], a[184:187], a[172:175], v[228:231]
    ds_read_b64_tr_b16 v[90:91], v29 offset:49664
    v_mfma_f32_16x16x32_bf16 v[140:143], a[188:191], a[160:163], v[140:143]
    buffer_load_dwordx4 v14, s[8:11], s46 offen offset:2048 lds
    v_mfma_f32_16x16x32_bf16 v[172:175], a[188:191], a[164:167], v[172:175]
    ds_read_b64_tr_b16 v[92:93], v29 offset:57344
    v_mfma_f32_16x16x32_bf16 v[204:207], a[188:191], a[168:171], v[204:207]
    ds_read_b64_tr_b16 v[94:95], v29 offset:57856
    v_mfma_f32_16x16x32_bf16 v[236:239], a[188:191], a[172:175], v[236:239]
    ds_read_b64_tr_b16 v[96:97], v30 offset:49152
    v_mfma_f32_16x16x32_bf16 v[144:147], a[192:195], a[160:163], v[144:147]
    ds_read_b64_tr_b16 v[98:99], v30 offset:49664
    v_mfma_f32_16x16x32_bf16 v[176:179], a[192:195], a[164:167], v[176:179]
    v_mfma_f32_16x16x32_bf16 v[208:211], a[192:195], a[168:171], v[208:211]
    buffer_load_dwordx4 v15, s[8:11], s46 offen offset:3072 lds
    v_mfma_f32_16x16x32_bf16 v[240:243], a[192:195], a[172:175], v[240:243]
    ds_read_b64_tr_b16 v[100:101], v30 offset:57344
    s_add_u32 s46, s46, 128
    v_mfma_f32_16x16x32_bf16 v[152:155], a[196:199], a[160:163], v[152:155]
    ds_read_b64_tr_b16 v[102:103], v30 offset:57856
    s_and_b32 s46, s46, 1023
    v_mfma_f32_16x16x32_bf16 v[184:187], a[196:199], a[164:167], v[184:187]
    ds_read_b64_tr_b16 v[104:105], v31 offset:49152
    s_add_u32 m0, s41, 0
    v_mfma_f32_16x16x32_bf16 v[216:219], a[196:199], a[168:171], v[216:219]
    ds_read_b64_tr_b16 v[106:107], v31 offset:49664
    v_mfma_f32_16x16x32_bf16 v[248:251], a[196:199], a[172:175], v[248:251]
    buffer_load_dwordx4 v2, s[24:27], s89 offen offset:0  lds
    v_mfma_f32_16x16x32_bf16 v[148:151], a[200:203], a[160:163], v[148:151]
    ds_read_b64_tr_b16 v[108:109], v31 offset:57344
    v_mfma_f32_16x16x32_bf16 v[180:183], a[200:203], a[164:167], v[180:183]
    ds_read_b64_tr_b16 v[110:111], v31 offset:57856
    v_mfma_f32_16x16x32_bf16 v[212:215], a[200:203], a[168:171], v[212:215]
    v_mfma_f32_16x16x32_bf16 v[244:247], a[200:203], a[172:175], v[244:247]
    v_mfma_f32_16x16x32_bf16 v[156:159], a[204:207], a[160:163], v[156:159]
    buffer_load_dwordx4 v2, s[24:27], s89 offen offset:1024  lds
    v_mfma_f32_16x16x32_bf16 v[188:191], a[204:207], a[164:167], v[188:191]
    v_mfma_f32_16x16x32_bf16 v[220:223], a[204:207], a[168:171], v[220:223]
    v_mfma_f32_16x16x32_bf16 v[252:255], a[204:207], a[172:175], v[252:255]
    s_waitcnt lgkmcnt(0)
    v_mfma_f32_16x16x32_bf16 v[128:131], v[80:83], v[64:67], v[128:131]
    ds_read_b64_tr_b16 a[176:177], v28 offset:53248
    s_add_u32 m0, s61, 0
    v_mfma_f32_16x16x32_bf16 v[160:163], v[80:83], v[68:71], v[160:163]
    ds_read_b64_tr_b16 a[178:179], v28 offset:53760
    s_load_dword s82, s[32:33], 0
    v_mfma_f32_16x16x32_bf16 v[192:195], v[80:83], v[72:75], v[192:195]
    buffer_load_dwordx4 v48, s[20:23], s3 offen offset:0 lds
    s_load_dword s83, s[32:33], 128
    v_mfma_f32_16x16x32_bf16 v[224:227], v[80:83], v[76:79], v[224:227]
    ds_read_b128 a[160:163], v23 offset:49152
    v_mfma_f32_16x16x32_bf16 v[136:139], v[84:87], v[64:67], v[136:139]
    ds_read_b128 a[164:167], v23 offset:51200
    v_mfma_f32_16x16x32_bf16 v[168:171], v[84:87], v[68:71], v[168:171]
    ds_read_b128 a[168:171], v23 offset:53248
    v_mfma_f32_16x16x32_bf16 v[200:203], v[84:87], v[72:75], v[200:203]
    ds_read_b128 a[172:175], v23 offset:55296
    v_mfma_f32_16x16x32_bf16 v[232:235], v[84:87], v[76:79], v[232:235]
    buffer_load_dwordx4 v49, s[20:23], s3 offen offset:1024 lds
    v_mfma_f32_16x16x32_bf16 v[132:135], v[88:91], v[64:67], v[132:135]
    ds_read_b64_tr_b16 a[180:181], v28 offset:61440
    v_mfma_f32_16x16x32_bf16 v[164:167], v[88:91], v[68:71], v[164:167]
    ds_read_b64_tr_b16 a[182:183], v28 offset:61952
    v_mfma_f32_16x16x32_bf16 v[196:199], v[88:91], v[72:75], v[196:199]
    ds_read_b64_tr_b16 a[184:185], v29 offset:53248
    v_mfma_f32_16x16x32_bf16 v[228:231], v[88:91], v[76:79], v[228:231]
    ds_read_b64_tr_b16 a[186:187], v29 offset:53760
    v_mfma_f32_16x16x32_bf16 v[140:143], v[92:95], v[64:67], v[140:143]
    buffer_load_dwordx4 v50, s[20:23], s3 offen offset:2048 lds
    v_mfma_f32_16x16x32_bf16 v[172:175], v[92:95], v[68:71], v[172:175]
    ds_read_b64_tr_b16 a[188:189], v29 offset:61440
    v_mfma_f32_16x16x32_bf16 v[204:207], v[92:95], v[72:75], v[204:207]
    ds_read_b64_tr_b16 a[190:191], v29 offset:61952
    v_mfma_f32_16x16x32_bf16 v[236:239], v[92:95], v[76:79], v[236:239]
    ds_read_b64_tr_b16 a[192:193], v30 offset:53248
    v_mfma_f32_16x16x32_bf16 v[144:147], v[96:99], v[64:67], v[144:147]
    ds_read_b64_tr_b16 a[194:195], v30 offset:53760
    v_mfma_f32_16x16x32_bf16 v[176:179], v[96:99], v[68:71], v[176:179]
    v_mfma_f32_16x16x32_bf16 v[208:211], v[96:99], v[72:75], v[208:211]
    buffer_load_dwordx4 v51, s[20:23], s3 offen offset:3072 lds
    s_lshr_b32 s3, s3, 5
    v_mfma_f32_16x16x32_bf16 v[240:243], v[96:99], v[76:79], v[240:243]
    ds_read_b64_tr_b16 a[196:197], v30 offset:61440
    v_mfma_f32_16x16x32_bf16 v[152:155], v[100:103], v[64:67], v[152:155]
    ds_read_b64_tr_b16 a[198:199], v30 offset:61952
    s_add_u32 m0, s61, 4096
    v_mfma_f32_16x16x32_bf16 v[184:187], v[100:103], v[68:71], v[184:187]
    ds_read_b64_tr_b16 a[200:201], v31 offset:53248
    v_mfma_f32_16x16x32_bf16 v[216:219], v[100:103], v[72:75], v[216:219]
    ds_read_b64_tr_b16 a[202:203], v31 offset:53760
    v_mfma_f32_16x16x32_bf16 v[248:251], v[100:103], v[76:79], v[248:251]
    buffer_load_dwordx4 v48, s[20:23], s39 offen offset:0 lds
    v_mfma_f32_16x16x32_bf16 v[148:151], v[104:107], v[64:67], v[148:151]
    ds_read_b64_tr_b16 a[204:205], v31 offset:61440
    v_mfma_f32_16x16x32_bf16 v[180:183], v[104:107], v[68:71], v[180:183]
    ds_read_b64_tr_b16 a[206:207], v31 offset:61952
    v_mfma_f32_16x16x32_bf16 v[212:215], v[104:107], v[72:75], v[212:215]
    v_mfma_f32_16x16x32_bf16 v[244:247], v[104:107], v[76:79], v[244:247]
    v_mfma_f32_16x16x32_bf16 v[156:159], v[108:111], v[64:67], v[156:159]
    buffer_load_dwordx4 v49, s[20:23], s39 offen offset:1024 lds
    v_mfma_f32_16x16x32_bf16 v[188:191], v[108:111], v[68:71], v[188:191]
    v_mfma_f32_16x16x32_bf16 v[220:223], v[108:111], v[72:75], v[220:223]
    v_mfma_f32_16x16x32_bf16 v[252:255], v[108:111], v[76:79], v[252:255]
    s_waitcnt vmcnt(8) lgkmcnt(0)
    s_barrier
    s_waitcnt lgkmcnt(0)
    s_min_u32 s82, s82, s83
    s_cmp_ge_u32 s82, 128
    s_cbranch_scc0 L_slow_14
L_back_15:
    v_mfma_f32_16x16x32_bf16 v[128:131], a[176:179], a[160:163], v[128:131]
    ds_read_b64_tr_b16 v[80:81], v24 offset:0
    v_mfma_f32_16x16x32_bf16 v[160:163], a[176:179], a[164:167], v[160:163]
    ds_read_b64_tr_b16 v[82:83], v24 offset:512
    v_mfma_f32_16x16x32_bf16 v[192:195], a[176:179], a[168:171], v[192:195]
    buffer_load_dwordx4 v50, s[20:23], s39 offen offset:2048 lds
    v_mfma_f32_16x16x32_bf16 v[224:227], a[176:179], a[172:175], v[224:227]
    ds_read_b128 v[64:67], v20 offset:0
    v_mfma_f32_16x16x32_bf16 v[136:139], a[180:183], a[160:163], v[136:139]
    ds_read_b128 v[68:71], v20 offset:2048
    v_mfma_f32_16x16x32_bf16 v[168:171], a[180:183], a[164:167], v[168:171]
    buffer_load_dwordx4 v51, s[20:23], s39 offen offset:3072 lds
    s_lshr_b32 s39, s39, 5
    v_mfma_f32_16x16x32_bf16 v[200:203], a[180:183], a[168:171], v[200:203]
    ds_read_b128 v[72:75], v20 offset:4096
    v_mfma_f32_16x16x32_bf16 v[232:235], a[180:183], a[172:175], v[232:235]
    ds_read_b128 v[76:79], v20 offset:6144
    v_mfma_f32_16x16x32_bf16 v[132:135], a[184:187], a[160:163], v[132:135]
    buffer_load_dwordx2 v[40:41], v34, s[16:19], s76 offen offset:0 sc1
    v_mfma_f32_16x16x32_bf16 v[164:167], a[184:187], a[164:167], v[164:167]
    ds_read_b64_tr_b16 v[84:85], v24 offset:8192
    v_mfma_f32_16x16x32_bf16 v[196:199], a[184:187], a[168:171], v[196:199]
    ds_read_b64_tr_b16 v[86:87], v24 offset:8704
    v_mfma_f32_16x16x32_bf16 v[228:231], a[184:187], a[172:175], v[228:231]
    ds_read_b64_tr_b16 v[88:89], v25 offset:0
    v_mfma_f32_16x16x32_bf16 v[140:143], a[188:191], a[160:163], v[140:143]
    buffer_load_dwordx2 v[42:43], v34, s[16:19], s76 offen offset:256 sc1
    v_mfma_f32_16x16x32_bf16 v[172:175], a[188:191], a[164:167], v[172:175]
    ds_read_b64_tr_b16 v[90:91], v25 offset:512
    v_mfma_f32_16x16x32_bf16 v[204:207], a[188:191], a[168:171], v[204:207]
    ds_read_b64_tr_b16 v[92:93], v25 offset:8192
    v_mfma_f32_16x16x32_bf16 v[236:239], a[188:191], a[172:175], v[236:239]
    buffer_load_dwordx2 v[44:45], v34, s[16:19], s76 offen offset:512 sc1
    v_mfma_f32_16x16x32_bf16 v[144:147], a[192:195], a[160:163], v[144:147]
    ds_read_b64_tr_b16 v[94:95], v25 offset:8704
    v_mfma_f32_16x16x32_bf16 v[176:179], a[192:195], a[164:167], v[176:179]
    ds_read_b64_tr_b16 v[96:97], v26 offset:0
    v_mfma_f32_16x16x32_bf16 v[208:211], a[192:195], a[168:171], v[208:211]
    ds_read_b64_tr_b16 v[98:99], v26 offset:512
    v_mfma_f32_16x16x32_bf16 v[240:243], a[192:195], a[172:175], v[240:243]
    buffer_load_dwordx2 v[46:47], v34, s[16:19], s76 offen offset:768 sc1
    s_mov_b32 m0, s38
    v_mfma_f32_16x16x32_bf16 v[152:155], a[196:199], a[160:163], v[152:155]
    ds_read_b64_tr_b16 v[100:101], v26 offset:8192
    v_mfma_f32_16x16x32_bf16 v[184:187], a[196:199], a[164:167], v[184:187]
    ds_read_b64_tr_b16 v[102:103], v26 offset:8704
    v_mfma_f32_16x16x32_bf16 v[216:219], a[196:199], a[168:171], v[216:219]
    buffer_load_dwordx4 v2, s[16:19], s36 offen sc1 lds
    s_add_u32 m0, s61, 8192
    v_mfma_f32_16x16x32_bf16 v[248:251], a[196:199], a[172:175], v[248:251]
    ds_read_b64_tr_b16 v[104:105], v27 offset:0
    v_mfma_f32_16x16x32_bf16 v[148:151], a[200:203], a[160:163], v[148:151]
    ds_read_b64_tr_b16 v[106:107], v27 offset:512
L_pad2:
    s_cbranch_execz L_return
    v_mfma_f32_16x16x32_bf16 v[180:183], a[200:203], a[164:167], v[180:183]
    buffer_load_dwordx4 v48, s[20:23], s40 offen offset:0 lds
    v_mfma_f32_16x16x32_bf16 v[212:215], a[200:203], a[168:171], v[212:215]
    ds_read_b64_tr_b16 v[108:109], v27 offset:8192
    v_mfma_f32_16x16x32_bf16 v[244:247], a[200:203], a[172:175], v[244:247]
    ds_read_b64_tr_b16 v[110:111], v27 offset:8704
    v_mfma_f32_16x16x32_bf16 v[156:159], a[204:207], a[160:163], v[156:159]
    buffer_load_dwordx4 v49, s[20:23], s40 offen offset:1024 lds
    v_mfma_f32_16x16x32_bf16 v[188:191], a[204:207], a[164:167], v[188:191]
    buffer_load_dwordx4 v50, s[20:23], s40 offen offset:2048 lds
    v_mfma_f32_16x16x32_bf16 v[220:223], a[204:207], a[168:171], v[220:223]
    v_mfma_f32_16x16x32_bf16 v[252:255], a[204:207], a[172:175], v[252:255]
    s_waitcnt lgkmcnt(0)
    v_mfma_f32_16x16x32_bf16 v[128:131], v[80:83], v[64:67], v[128:131]
    ds_read_b64_tr_b16 a[176:177], v24 offset:4096
    v_add_u32 v4, 18016, v56
    v_mfma_f32_16x16x32_bf16 v[160:163], v[80:83], v[68:71], v[160:163]
    ds_read_b64_tr_b16 a[178:179], v24 offset:4608
    s_waitcnt vmcnt(12)
    v_mfma_f32_16x16x32_bf16 v[192:195], v[80:83], v[72:75], v[192:195]
    ds_read_b64_tr_b16 a[48:49], v52 offset:0
    ds_read_b64_tr_b16 a[50:51], v52 offset:2048
    v_mfma_f32_16x16x32_bf16 v[224:227], v[80:83], v[76:79], v[224:227]
    buffer_load_dwordx4 v51, s[20:23], s40 offen offset:3072 lds
    s_lshr_b32 s40, s40, 5
    v_mfma_f32_16x16x32_bf16 v[136:139], v[84:87], v[64:67], v[136:139]
    ds_read_b128 a[160:163], v21 offset:0
    ds_read_b64_tr_b16 a[52:53], v53 offset:0
    v_mfma_f32_16x16x32_bf16 v[168:171], v[84:87], v[68:71], v[168:171]
    ds_read_b128 a[164:167], v21 offset:2048
    ds_read_b64_tr_b16 a[54:55], v53 offset:2048
    v_mfma_f32_16x16x32_bf16 v[200:203], v[84:87], v[72:75], v[200:203]
    ds_read_b128 a[168:171], v21 offset:4096
    ds_read_b128 a[172:175], v21 offset:6144
    v_mfma_f32_16x16x32_bf16 v[232:235], v[84:87], v[76:79], v[232:235]
    ds_read_b64_tr_b16 a[180:181], v24 offset:12288
    v_add_u32 v5, 13372, v56
    v_mfma_f32_16x16x32_bf16 v[132:135], v[88:91], v[64:67], v[132:135]
    v_mul_u32_u24 v36, s77, v36
    s_add_u32 m0, s61, 49152
    v_mfma_f32_16x16x32_bf16 v[164:167], v[88:91], v[68:71], v[164:167]
    buffer_load_dwordx4 v48, s[20:23], s50 offen offset:0 lds
    ds_read_b64_tr_b16 a[182:183], v24 offset:12800
    v_mfma_f32_16x16x32_bf16 v[196:199], v[88:91], v[72:75], v[196:199]
    ds_read_b64_tr_b16 a[56:57], v62 offset:0
    ds_read_b64_tr_b16 a[184:185], v25 offset:4096
    v_mfma_f32_16x16x32_bf16 v[228:231], v[88:91], v[76:79], v[228:231]
    ds_read_b64_tr_b16 a[58:59], v62 offset:2048
    ds_read_b64_tr_b16 a[186:187], v25 offset:4608
    v_mfma_f32_16x16x32_bf16 v[140:143], v[92:95], v[64:67], v[140:143]
    buffer_load_dwordx4 v49, s[20:23], s50 offen offset:1024 lds
    v_add_u32 v0, 4, v1
    v_mfma_f32_16x16x32_bf16 v[172:175], v[92:95], v[68:71], v[172:175]
    ds_read_b64_tr_b16 a[188:189], v25 offset:12288
    v_min_u32 v0, 32, v0
    v_mfma_f32_16x16x32_bf16 v[204:207], v[92:95], v[72:75], v[204:207]
    ds_read_b64_tr_b16 a[190:191], v25 offset:12800
    ds_read_b64_tr_b16 a[60:61], v123 offset:0
    v_mfma_f32_16x16x32_bf16 v[236:239], v[92:95], v[76:79], v[236:239]
    ds_read_b64_tr_b16 a[192:193], v26 offset:4096
    v_lshrrev_b32 v0, 5, v0
    v_mfma_f32_16x16x32_bf16 v[144:147], v[96:99], v[64:67], v[144:147]
    ds_read_b64_tr_b16 a[62:63], v123 offset:2048
    ds_read_b64_tr_b16 a[194:195], v26 offset:4608
    v_mfma_f32_16x16x32_bf16 v[176:179], v[96:99], v[68:71], v[176:179]
    v_mfma_f32_16x16x32_bf16 v[208:211], v[96:99], v[72:75], v[208:211]
    buffer_load_dwordx4 v50, s[20:23], s50 offen offset:2048 lds
    ds_read_b64_tr_b16 a[196:197], v26 offset:12288
    v_mfma_f32_16x16x32_bf16 v[240:243], v[96:99], v[76:79], v[240:243]
    ds_read_b64_tr_b16 a[198:199], v26 offset:12800
    v_mul_u32_u24 v36, v0, v36
    v_mfma_f32_16x16x32_bf16 v[152:155], v[100:103], v[64:67], v[152:155]
    ds_read_b64_tr_b16 a[200:201], v27 offset:4096
    s_waitcnt vmcnt(12)
    v_mfma_f32_16x16x32_bf16 v[184:187], v[100:103], v[68:71], v[184:187]
    ds_read_b64_tr_b16 a[64:65], v52 offset:4096
    ds_read_b64_tr_b16 a[66:67], v52 offset:6144
    v_mfma_f32_16x16x32_bf16 v[216:219], v[100:103], v[72:75], v[216:219]
    ds_read_b64_tr_b16 a[202:203], v27 offset:4608
    v_lshlrev_b32 v36, 16, v36
    v_mfma_f32_16x16x32_bf16 v[248:251], v[100:103], v[76:79], v[248:251]
    buffer_load_dwordx4 v51, s[20:23], s50 offen offset:3072 lds
    s_lshr_b32 s50, s50, 5
    v_mfma_f32_16x16x32_bf16 v[148:151], v[104:107], v[64:67], v[148:151]
    ds_read_b64_tr_b16 a[204:205], v27 offset:12288
    ds_read_b64_tr_b16 a[68:69], v53 offset:4096
    v_mfma_f32_16x16x32_bf16 v[180:183], v[104:107], v[68:71], v[180:183]
    ds_read_b64_tr_b16 a[206:207], v27 offset:12800
    ds_read_b64_tr_b16 a[70:71], v53 offset:6144
    v_mfma_f32_16x16x32_bf16 v[212:215], v[104:107], v[72:75], v[212:215]
    v_mov_b32 v6, 0
    v_mfma_f32_16x16x32_bf16 v[244:247], v[104:107], v[76:79], v[244:247]
    s_add_u32 m0, s61, 53248
    v_mfma_f32_16x16x32_bf16 v[156:159], v[108:111], v[64:67], v[156:159]
    buffer_load_dwordx4 v48, s[20:23], s51 offen offset:0 lds
    v_mfma_f32_16x16x32_bf16 v[188:191], v[108:111], v[68:71], v[188:191]
    v_mfma_f32_16x16x32_bf16 v[220:223], v[108:111], v[72:75], v[220:223]
    v_mfma_f32_16x16x32_bf16 v[252:255], v[108:111], v[76:79], v[252:255]
    s_waitcnt vmcnt(9) lgkmcnt(1)
    s_barrier
    v_mfma_f32_16x16x32_bf16 v[128:131], a[176:179], a[160:163], v[128:131]
    ds_read_b64_tr_b16 a[72:73], v62 offset:4096
    v_add_u32 v33, 2048, v35
    v_mfma_f32_16x16x32_bf16 v[160:163], a[176:179], a[164:167], v[160:163]
    ds_read2_b32 v[72:73], v35 offset0:0 offset1:32
    ds_read_b64_tr_b16 a[74:75], v62 offset:6144
    v_mfma_f32_16x16x32_bf16 v[192:195], a[176:179], a[168:171], v[192:195]
    ds_read2_b32 v[74:75], v35 offset0:64 offset1:96
    ds_read2_b32 v[76:77], v35 offset0:128 offset1:160
    v_mfma_f32_16x16x32_bf16 v[224:227], a[176:179], a[172:175], v[224:227]
    ds_read2_b32 v[78:79], v35 offset0:192 offset1:224
    ds_read2_b32 v[80:81], v33 offset0:0 offset1:32
    v_mfma_f32_16x16x32_bf16 v[136:139], a[180:183], a[160:163], v[136:139]
    buffer_load_dwordx4 v49, s[20:23], s51 offen offset:1024 lds
    ds_read2_b32 v[82:83], v33 offset0:64 offset1:96
    v_mfma_f32_16x16x32_bf16 v[168:171], a[180:183], a[164:167], v[168:171]
    ds_read2_b32 v[84:85], v33 offset0:128 offset1:160
    ds_read2_b32 v[86:87], v33 offset0:192 offset1:224
    v_mfma_f32_16x16x32_bf16 v[200:203], a[180:183], a[168:171], v[200:203]
    ds_read_b64_tr_b16 a[76:77], v123 offset:4096
    s_waitcnt vmcnt(11)
    v_mfma_f32_16x16x32_bf16 v[232:235], a[180:183], a[172:175], v[232:235]
    ds_read_b64_tr_b16 a[78:79], v123 offset:6144
    v_cvt_pk_bf16_f32 v64, -v40, -v40
    v_mfma_f32_16x16x32_bf16 v[132:135], a[184:187], a[160:163], v[132:135]
    v_mov_b32 v65, v64
    v_cvt_pk_bf16_f32 v66, -v42, -v42
    v_mfma_f32_16x16x32_bf16 v[164:167], a[184:187], a[164:167], v[164:167]
    buffer_load_dwordx4 v50, s[20:23], s51 offen offset:2048 lds
    v_mov_b32 v67, v66
    v_mfma_f32_16x16x32_bf16 v[196:199], a[184:187], a[168:171], v[196:199]
    v_cvt_pk_bf16_f32 v68, -v44, -v44
    v_mov_b32 v69, v68
    v_mfma_f32_16x16x32_bf16 v[228:231], a[184:187], a[172:175], v[228:231]
    v_cvt_pk_bf16_f32 v70, -v46, -v46
    v_mov_b32 v71, v70
    v_mfma_f32_16x16x32_bf16 v[140:143], a[188:191], a[160:163], v[140:143]
    s_waitcnt lgkmcnt(2)
    s_load_dword s44, s[16:17], s60 offset:0
    v_mfma_f32_16x16x32_bf16 v[172:175], a[188:191], a[164:167], v[172:175]
    s_load_dword s45, s[16:17], s60 offset:128
    s_load_dword s46, s[16:17], s60 offset:256
    v_mfma_f32_16x16x32_bf16 v[204:207], a[188:191], a[168:171], v[204:207]
    s_load_dword s47, s[16:17], s60 offset:384
    s_load_dword s42, s[16:17], s60 offset:512
    v_mfma_f32_16x16x32_bf16 v[236:239], a[188:191], a[172:175], v[236:239]
    buffer_load_dwordx4 v51, s[20:23], s51 offen offset:3072 lds
    s_lshr_b32 s51, s51, 5
    v_mfma_f32_16x16x32_bf16 v[144:147], a[192:195], a[160:163], v[144:147]
    s_load_dword s43, s[16:17], s60 offset:640
    s_load_dword s98, s[16:17], s60 offset:768
    v_mfma_f32_16x16x32_bf16 v[176:179], a[192:195], a[164:167], v[176:179]
    s_load_dword s99, s[16:17], s60 offset:896
    v_add_f32 v72, v72, v76
    v_mfma_f32_16x16x32_bf16 v[208:211], a[192:195], a[168:171], v[208:211]
    v_add_f32 v73, v73, v77
    v_add_f32 v74, v74, v78
    v_mfma_f32_16x16x32_bf16 v[240:243], a[192:195], a[172:175], v[240:243]
    v_add_f32 v75, v75, v79
    v_add_f32 v72, v72, v74
    v_mfma_f32_16x16x32_bf16 v[152:155], a[196:199], a[160:163], v[152:155]
    v_add_f32 v73, v73, v75
    s_waitcnt vmcnt(8)
    v_mfma_f32_16x16x32_bf16 v[184:187], a[196:199], a[164:167], v[184:187]
    ds_read_b64_tr_b16 a[80:81], v52 offset:8192
    ds_read_b64_tr_b16 a[82:83], v52 offset:10240
    v_mfma_f32_16x16x32_bf16 v[216:219], a[196:199], a[168:171], v[216:219]
    v_add_f32 v72, v72, v73
    v_cvt_pk_bf16_f32 v73, v72, v72
    v_mfma_f32_16x16x32_bf16 v[248:251], a[196:199], a[172:175], v[248:251]
    v_and_b32 v73, 0xffff0000, v73
    v_sub_f32 v73, v72, v73
    v_mfma_f32_16x16x32_bf16 v[148:151], a[200:203], a[160:163], v[148:151]
    v_cvt_pk_bf16_f32 v72, v72, v73
    s_add_u32 m0, s64, 0
    v_mfma_f32_16x16x32_bf16 v[180:183], a[200:203], a[164:167], v[180:183]
    buffer_load_dwordx4 v2, s[24:27], s66 offen offset:0  lds
    ds_read_b64_tr_b16 a[84:85], v53 offset:8192
    v_mfma_f32_16x16x32_bf16 v[212:215], a[200:203], a[168:171], v[212:215]
    ds_read_b64_tr_b16 a[86:87], v53 offset:10240
    v_mov_b32 v73, 0
    v_mfma_f32_16x16x32_bf16 v[244:247], a[200:203], a[172:175], v[244:247]
    buffer_load_dwordx4 v2, s[24:27], s66 offen offset:1024  lds
    v_add_f32 v80, v80, v84
    v_mfma_f32_16x16x32_bf16 v[156:159], a[204:207], a[160:163], v[156:159]
    v_add_f32 v81, v81, v85
    v_add_f32 v82, v82, v86
    v_mfma_f32_16x16x32_bf16 v[188:191], a[204:207], a[164:167], v[188:191]
    v_add_f32 v83, v83, v87
    v_add_f32 v80, v80, v82
    v_mfma_f32_16x16x32_bf16 v[220:223], a[204:207], a[168:171], v[220:223]
    v_add_f32 v81, v81, v83
    v_add_f32 v80, v80, v81
    v_mfma_f32_16x16x32_bf16 v[252:255], a[204:207], a[172:175], v[252:255]
    v_cvt_pk_bf16_f32 v81, v80, v80
    v_and_b32 v81, 0xffff0000, v81
    v_sub_f32 v81, v80, v81
    v_cvt_pk_bf16_f32 v80, v80, v81
    v_mov_b32 v81, 0
    s_waitcnt lgkmcnt(0)
    s_min_u32 s44, s44, s45
    s_min_u32 s44, s44, s46
    s_min_u32 s44, s44, s47
    s_min_u32 s44, s44, s42
    s_min_u32 s44, s44, s43
    s_min_u32 s44, s44, s98
    s_min_u32 s44, s44, s99
    s_cmp_ge_u32 s44, 1
    s_cbranch_scc0 L_slow_16
L_back_17:
    s_barrier
    v_mfma_f32_16x16x4_4b_bf16 v[128:143], v[72:73], v[64:65], v[128:143]
    ds_read_b64_tr_b16 a[88:89], v62 offset:8192
    ds_read_b64_tr_b16 a[90:91], v62 offset:10240
    v_rcp_f32 v8, v41
    s_add_u32 m0, s63, 13920
    v_mul_f32 v16, v41, v41
    v_mfma_f32_16x16x4_4b_bf16 v[144:159], v[80:81], v[64:65], v[144:159]
    buffer_load_dwordx4 v2, s[16:19], s65 offen offset:0 sc1 lds
    ds_read_b64_tr_b16 a[92:93], v123 offset:8192
    v_mul_f32 v9, v8, v8
    v_mul_f32 v9, v9, v8
    v_mul_f32 v8, 0xc0135761, v8
    v_mul_f32 v9, 0xbdd2d3e8, v9
    v_mfma_f32_16x16x4_4b_bf16 v[160:175], v[72:73], v[66:67], v[160:175]
    ds_write2st64_b32 v4, v6, v6 offset0:0 offset1:1
    ds_read_b64_tr_b16 a[94:95], v123 offset:10240
    v_rcp_f32 v10, v43
    v_mul_f32 v17, v43, v43
    v_mul_f32 v11, v10, v10
    v_mfma_f32_16x16x4_4b_bf16 v[176:191], v[80:81], v[66:67], v[176:191]
    buffer_load_dwordx4 v2, s[16:19], s65 offen offset:1024 sc1 lds
    buffer_load_dwordx4 v2, s[16:19], s65 offen offset:2048 sc1 lds
    v_mul_f32 v11, v11, v10
    v_mul_f32 v10, 0xc0135761, v10
    v_mul_f32 v11, 0xbdd2d3e8, v11
    v_mfma_f32_16x16x4_4b_bf16 v[192:207], v[72:73], v[68:69], v[192:207]
    ds_write2st64_b32 v5, v6, v6 offset0:0 offset1:1
    buffer_load_dwordx4 v2, s[16:19], s65 offen offset:3072 sc1 lds
    s_add_u32 m0, s63, 9276
    v_rcp_f32 v12, v45
    v_mul_f32 v18, v45, v45
    v_mfma_f32_16x16x4_4b_bf16 v[208:223], v[80:81], v[68:69], v[208:223]
    buffer_load_dwordx4 v2, s[16:19], s65 offen offset:0 sc1 lds
    ds_write_b32 v57, v36
    v_mul_f32 v13, v12, v12
    v_mul_f32 v13, v13, v12
    v_mul_f32 v12, 0xc0135761, v12
    v_mul_f32 v13, 0xbdd2d3e8, v13
    v_mfma_f32_16x16x4_4b_bf16 v[224:239], v[72:73], v[70:71], v[224:239]
    buffer_load_dwordx4 v2, s[16:19], s65 offen offset:1024 sc1 lds
    buffer_load_dwordx4 v2, s[16:19], s65 offen offset:2048 sc1 lds
    v_rcp_f32 v14, v47
    v_mul_f32 v19, v47, v47
    v_mul_f32 v15, v14, v14
    v_mfma_f32_16x16x4_4b_bf16 v[240:255], v[80:81], v[70:71], v[240:255]
    buffer_load_dwordx4 v2, s[16:19], s65 offen offset:3072 sc1 lds
    v_mul_f32 v15, v15, v14
    v_mul_f32 v14, 0xc0135761, v14
    v_mul_f32 v15, 0xbdd2d3e8, v15
    v_pk_mul_f32 v[96:97], v[128:129], v[128:129]
    v_pk_mul_f32 v[98:99], v[130:131], v[130:131]
    v_pk_mul_f32 v[100:101], v[132:133], v[132:133]
    v_pk_mul_f32 v[102:103], v[134:135], v[134:135]
    v_pk_fma_f32 v[96:97], v[96:97], v[8:9], v[8:9] op_sel:[0,1,0] op_sel_hi:[1,1,0]
    v_pk_fma_f32 v[98:99], v[98:99], v[8:9], v[8:9] op_sel:[0,1,0] op_sel_hi:[1,1,0]
    v_pk_fma_f32 v[100:101], v[100:101], v[8:9], v[8:9] op_sel:[0,1,0] op_sel_hi:[1,1,0]
    v_pk_fma_f32 v[102:103], v[102:103], v[8:9], v[8:9] op_sel:[0,1,0] op_sel_hi:[1,1,0]
    v_pk_mul_f32 v[96:97], v[96:97], v[128:129]
    v_pk_mul_f32 v[98:99], v[98:99], v[130:131]
    v_pk_mul_f32 v[100:101], v[100:101], v[132:133]
    v_pk_mul_f32 v[102:103], v[102:103], v[134:135]
    buffer_load_dwordx4 v[40:43], v113, s[8:11], s70 offen
    v_exp_f32 v96, v96
    v_exp_f32 v97, v97
    v_exp_f32 v98, v98
    v_exp_f32 v99, v99
    v_exp_f32 v100, v100
    v_exp_f32 v101, v101
    v_exp_f32 v102, v102
    v_exp_f32 v103, v103
    buffer_load_dwordx4 v[44:47], v113, s[8:11], s71 offen
    v_pk_mul_f32 v[128:129], v[128:129], v[136:137]
    v_pk_mul_f32 v[130:131], v[130:131], v[138:139]
    v_pk_mul_f32 v[132:133], v[132:133], v[140:141]
    v_pk_mul_f32 v[134:135], v[134:135], v[142:143]
    v_pk_fma_f32 v[96:97], v[96:97], v[16:17], v[16:17] op_sel:[0,0,0] op_sel_hi:[1,0,0]
    v_pk_fma_f32 v[98:99], v[98:99], v[16:17], v[16:17] op_sel:[0,0,0] op_sel_hi:[1,0,0]
    v_pk_fma_f32 v[100:101], v[100:101], v[16:17], v[16:17] op_sel:[0,0,0] op_sel_hi:[1,0,0]
    v_pk_fma_f32 v[102:103], v[102:103], v[16:17], v[16:17] op_sel:[0,0,0] op_sel_hi:[1,0,0]
    buffer_load_dwordx2 v[124:125], v114, s[16:19], s72 offen sc1
    v_rcp_f32 v96, v96
    v_rcp_f32 v97, v97
    v_rcp_f32 v98, v98
    v_rcp_f32 v99, v99
    v_rcp_f32 v100, v100
    v_rcp_f32 v101, v101
    v_rcp_f32 v102, v102
    v_rcp_f32 v103, v103
    buffer_load_dwordx2 v[126:127], v114, s[16:19], s73 offen sc1
    v_pk_mul_f32 v[128:129], v[128:129], v[96:97]
    v_pk_mul_f32 v[130:131], v[130:131], v[98:99]
    v_pk_mul_f32 v[132:133], v[132:133], v[100:101]
    v_pk_mul_f32 v[134:135], v[134:135], v[102:103]
    v_cvt_pk_bf16_f32 v136, v128, v129
    v_cvt_pk_bf16_f32 v137, v130, v131
    v_cvt_pk_bf16_f32 v138, v132, v133
    v_cvt_pk_bf16_f32 v139, v134, v135
    buffer_store_dwordx4 v[136:139], v2, s[16:19], s48 offen offset:0 sc1
    s_waitcnt lgkmcnt(0)
    v_pk_mul_f32 v[104:105], v[144:145], v[144:145]
    v_pk_mul_f32 v[106:107], v[146:147], v[146:147]
    v_pk_mul_f32 v[108:109], v[148:149], v[148:149]
    v_pk_mul_f32 v[110:111], v[150:151], v[150:151]
    v_pk_fma_f32 v[104:105], v[104:105], v[8:9], v[8:9] op_sel:[0,1,0] op_sel_hi:[1,1,0]
    v_pk_fma_f32 v[106:107], v[106:107], v[8:9], v[8:9] op_sel:[0,1,0] op_sel_hi:[1,1,0]
    v_pk_fma_f32 v[108:109], v[108:109], v[8:9], v[8:9] op_sel:[0,1,0] op_sel_hi:[1,1,0]
    v_pk_fma_f32 v[110:111], v[110:111], v[8:9], v[8:9] op_sel:[0,1,0] op_sel_hi:[1,1,0]
    v_pk_mul_f32 v[104:105], v[104:105], v[144:145]
    v_pk_mul_f32 v[106:107], v[106:107], v[146:147]
    v_pk_mul_f32 v[108:109], v[108:109], v[148:149]
    v_pk_mul_f32 v[110:111], v[110:111], v[150:151]
    v_exp_f32 v104, v104
    v_exp_f32 v105, v105
    v_exp_f32 v106, v106
    v_exp_f32 v107, v107
    v_exp_f32 v108, v108
    v_exp_f32 v109, v109
    v_exp_f32 v110, v110
    v_exp_f32 v111, v111
    v_pk_mul_f32 v[144:145], v[144:145], v[152:153]
    v_pk_mul_f32 v[146:147], v[146:147], v[154:155]
    v_pk_mul_f32 v[148:149], v[148:149], v[156:157]
    v_pk_mul_f32 v[150:151], v[150:151], v[158:159]
    v_pk_fma_f32 v[104:105], v[104:105], v[16:17], v[16:17] op_sel:[0,0,0] op_sel_hi:[1,0,0]
    v_pk_fma_f32 v[106:107], v[106:107], v[16:17], v[16:17] op_sel:[0,0,0] op_sel_hi:[1,0,0]
    v_pk_fma_f32 v[108:109], v[108:109], v[16:17], v[16:17] op_sel:[0,0,0] op_sel_hi:[1,0,0]
    v_pk_fma_f32 v[110:111], v[110:111], v[16:17], v[16:17] op_sel:[0,0,0] op_sel_hi:[1,0,0]
    v_rcp_f32 v104, v104
    v_rcp_f32 v105, v105
    v_rcp_f32 v106, v106
    v_rcp_f32 v107, v107
    v_rcp_f32 v108, v108
    v_rcp_f32 v109, v109
    v_rcp_f32 v110, v110
    v_rcp_f32 v111, v111
    v_pk_mul_f32 v[144:145], v[144:145], v[104:105]
    v_pk_mul_f32 v[146:147], v[146:147], v[106:107]
    v_pk_mul_f32 v[148:149], v[148:149], v[108:109]
    v_pk_mul_f32 v[150:151], v[150:151], v[110:111]
    v_cvt_pk_bf16_f32 v152, v144, v145
    v_cvt_pk_bf16_f32 v153, v146, v147
    v_cvt_pk_bf16_f32 v154, v148, v149
    v_cvt_pk_bf16_f32 v155, v150, v151
    buffer_store_dwordx4 v[152:155], v2, s[16:19], s48 offen offset:1024 sc1
    v_pk_mul_f32 v[96:97], v[160:161], v[160:161]
    v_pk_mul_f32 v[98:99], v[162:163], v[162:163]
    v_pk_mul_f32 v[100:101], v[164:165], v[164:165]
    v_pk_mul_f32 v[102:103], v[166:167], v[166:167]
    v_pk_fma_f32 v[96:97], v[96:97], v[10:11], v[10:11] op_sel:[0,1,0] op_sel_hi:[1,1,0]
    v_pk_fma_f32 v[98:99], v[98:99], v[10:11], v[10:11] op_sel:[0,1,0] op_sel_hi:[1,1,0]
    v_pk_fma_f32 v[100:101], v[100:101], v[10:11], v[10:11] op_sel:[0,1,0] op_sel_hi:[1,1,0]
    v_pk_fma_f32 v[102:103], v[102:103], v[10:11], v[10:11] op_sel:[0,1,0] op_sel_hi:[1,1,0]
    v_pk_mul_f32 v[96:97], v[96:97], v[160:161]
    v_pk_mul_f32 v[98:99], v[98:99], v[162:163]
    v_pk_mul_f32 v[100:101], v[100:101], v[164:165]
    v_pk_mul_f32 v[102:103], v[102:103], v[166:167]
    v_exp_f32 v96, v96
    v_exp_f32 v97, v97
    v_exp_f32 v98, v98
    v_exp_f32 v99, v99
    v_exp_f32 v100, v100
    v_exp_f32 v101, v101
    v_exp_f32 v102, v102
    v_exp_f32 v103, v103
    v_pk_mul_f32 v[160:161], v[160:161], v[168:169]
    v_pk_mul_f32 v[162:163], v[162:163], v[170:171]
    v_pk_mul_f32 v[164:165], v[164:165], v[172:173]
    v_pk_mul_f32 v[166:167], v[166:167], v[174:175]
    v_pk_fma_f32 v[96:97], v[96:97], v[16:17], v[16:17] op_sel:[0,1,1] op_sel_hi:[1,1,1]
    v_pk_fma_f32 v[98:99], v[98:99], v[16:17], v[16:17] op_sel:[0,1,1] op_sel_hi:[1,1,1]
    v_pk_fma_f32 v[100:101], v[100:101], v[16:17], v[16:17] op_sel:[0,1,1] op_sel_hi:[1,1,1]
    v_pk_fma_f32 v[102:103], v[102:103], v[16:17], v[16:17] op_sel:[0,1,1] op_sel_hi:[1,1,1]
    v_rcp_f32 v96, v96
    v_rcp_f32 v97, v97
    v_rcp_f32 v98, v98
    v_rcp_f32 v99, v99
    v_rcp_f32 v100, v100
    v_rcp_f32 v101, v101
    v_rcp_f32 v102, v102
    v_rcp_f32 v103, v103
    v_pk_mul_f32 v[160:161], v[160:161], v[96:97]
    v_pk_mul_f32 v[162:163], v[162:163], v[98:99]
    v_pk_mul_f32 v[164:165], v[164:165], v[100:101]
    v_pk_mul_f32 v[166:167], v[166:167], v[102:103]
    v_cvt_pk_bf16_f32 v168, v160, v161
    v_cvt_pk_bf16_f32 v169, v162, v163
    v_cvt_pk_bf16_f32 v170, v164, v165
    v_cvt_pk_bf16_f32 v171, v166, v167
    buffer_store_dwordx4 v[168:171], v32, s[16:19], s48 offen offset:0 sc1
    v_pk_mul_f32 v[104:105], v[176:177], v[176:177]
    v_pk_mul_f32 v[106:107], v[178:179], v[178:179]
    v_pk_mul_f32 v[108:109], v[180:181], v[180:181]
    v_pk_mul_f32 v[110:111], v[182:183], v[182:183]
    v_pk_fma_f32 v[104:105], v[104:105], v[10:11], v[10:11] op_sel:[0,1,0] op_sel_hi:[1,1,0]
    v_pk_fma_f32 v[106:107], v[106:107], v[10:11], v[10:11] op_sel:[0,1,0] op_sel_hi:[1,1,0]
    v_pk_fma_f32 v[108:109], v[108:109], v[10:11], v[10:11] op_sel:[0,1,0] op_sel_hi:[1,1,0]
    v_pk_fma_f32 v[110:111], v[110:111], v[10:11], v[10:11] op_sel:[0,1,0] op_sel_hi:[1,1,0]
    v_pk_mul_f32 v[104:105], v[104:105], v[176:177]
    v_pk_mul_f32 v[106:107], v[106:107], v[178:179]
    v_pk_mul_f32 v[108:109], v[108:109], v[180:181]
    v_pk_mul_f32 v[110:111], v[110:111], v[182:183]
    v_exp_f32 v104, v104
    v_exp_f32 v105, v105
    v_exp_f32 v106, v106
    v_exp_f32 v107, v107
    v_exp_f32 v108, v108
    v_exp_f32 v109, v109
    v_exp_f32 v110, v110
    v_exp_f32 v111, v111
    v_pk_mul_f32 v[176:177], v[176:177], v[184:185]
    v_pk_mul_f32 v[178:179], v[178:179], v[186:187]
    v_pk_mul_f32 v[180:181], v[180:181], v[188:189]
    v_pk_mul_f32 v[182:183], v[182:183], v[190:191]
    v_pk_fma_f32 v[104:105], v[104:105], v[16:17], v[16:17] op_sel:[0,1,1] op_sel_hi:[1,1,1]
    v_pk_fma_f32 v[106:107], v[106:107], v[16:17], v[16:17] op_sel:[0,1,1] op_sel_hi:[1,1,1]
    v_pk_fma_f32 v[108:109], v[108:109], v[16:17], v[16:17] op_sel:[0,1,1] op_sel_hi:[1,1,1]
    v_pk_fma_f32 v[110:111], v[110:111], v[16:17], v[16:17] op_sel:[0,1,1] op_sel_hi:[1,1,1]
    v_rcp_f32 v104, v104
    v_rcp_f32 v105, v105
    v_rcp_f32 v106, v106
    v_rcp_f32 v107, v107
    v_rcp_f32 v108, v108
    v_rcp_f32 v109, v109
    v_rcp_f32 v110, v110
    v_rcp_f32 v111, v111
    v_pk_mul_f32 v[176:177], v[176:177], v[104:105]
    v_pk_mul_f32 v[178:179], v[178:179], v[106:107]
    v_pk_mul_f32 v[180:181], v[180:181], v[108:109]
    v_pk_mul_f32 v[182:183], v[182:183], v[110:111]
    v_cvt_pk_bf16_f32 v184, v176, v177
    v_cvt_pk_bf16_f32 v185, v178, v179
    v_cvt_pk_bf16_f32 v186, v180, v181
    v_cvt_pk_bf16_f32 v187, v182, v183
    buffer_store_dwordx4 v[184:187], v32, s[16:19], s48 offen offset:1024 sc1
    v_pk_mul_f32 v[96:97], v[192:193], v[192:193]
    v_pk_mul_f32 v[98:99], v[194:195], v[194:195]
    v_pk_mul_f32 v[100:101], v[196:197], v[196:197]
    v_pk_mul_f32 v[102:103], v[198:199], v[198:199]
    v_pk_fma_f32 v[96:97], v[96:97], v[12:13], v[12:13] op_sel:[0,1,0] op_sel_hi:[1,1,0]
    v_pk_fma_f32 v[98:99], v[98:99], v[12:13], v[12:13] op_sel:[0,1,0] op_sel_hi:[1,1,0]
    v_pk_fma_f32 v[100:101], v[100:101], v[12:13], v[12:13] op_sel:[0,1,0] op_sel_hi:[1,1,0]
    v_pk_fma_f32 v[102:103], v[102:103], v[12:13], v[12:13] op_sel:[0,1,0] op_sel_hi:[1,1,0]
    v_pk_mul_f32 v[96:97], v[96:97], v[192:193]
    v_pk_mul_f32 v[98:99], v[98:99], v[194:195]
    v_pk_mul_f32 v[100:101], v[100:101], v[196:197]
    v_pk_mul_f32 v[102:103], v[102:103], v[198:199]
    v_exp_f32 v96, v96
    v_exp_f32 v97, v97
    v_exp_f32 v98, v98
    v_exp_f32 v99, v99
    v_exp_f32 v100, v100
    v_exp_f32 v101, v101
    v_exp_f32 v102, v102
    v_exp_f32 v103, v103
    v_pk_mul_f32 v[192:193], v[192:193], v[200:201]
    v_pk_mul_f32 v[194:195], v[194:195], v[202:203]
    v_pk_mul_f32 v[196:197], v[196:197], v[204:205]
    v_pk_mul_f32 v[198:199], v[198:199], v[206:207]
    v_pk_fma_f32 v[96:97], v[96:97], v[18:19], v[18:19] op_sel:[0,0,0] op_sel_hi:[1,0,0]
    v_pk_fma_f32 v[98:99], v[98:99], v[18:19], v[18:19] op_sel:[0,0,0] op_sel_hi:[1,0,0]
    v_pk_fma_f32 v[100:101], v[100:101], v[18:19], v[18:19] op_sel:[0,0,0] op_sel_hi:[1,0,0]
    v_pk_fma_f32 v[102:103], v[102:103], v[18:19], v[18:19] op_sel:[0,0,0] op_sel_hi:[1,0,0]
    v_rcp_f32 v96, v96
    v_rcp_f32 v97, v97
    v_rcp_f32 v98, v98
    v_rcp_f32 v99, v99
    v_rcp_f32 v100, v100
    v_rcp_f32 v101, v101
    v_rcp_f32 v102, v102
    v_rcp_f32 v103, v103
    v_pk_mul_f32 v[192:193], v[192:193], v[96:97]
    v_pk_mul_f32 v[194:195], v[194:195], v[98:99]
    v_pk_mul_f32 v[196:197], v[196:197], v[100:101]
    v_pk_mul_f32 v[198:199], v[198:199], v[102:103]
    v_cvt_pk_bf16_f32 v200, v192, v193
    v_cvt_pk_bf16_f32 v201, v194, v195
    v_cvt_pk_bf16_f32 v202, v196, v197
    v_cvt_pk_bf16_f32 v203, v198, v199
    buffer_store_dwordx4 v[200:203], v2, s[16:19], s49 offen offset:0 sc1
    v_pk_mul_f32 v[104:105], v[208:209], v[208:209]
    v_pk_mul_f32 v[106:107], v[210:211], v[210:211]
    v_pk_mul_f32 v[108:109], v[212:213], v[212:213]
    v_pk_mul_f32 v[110:111], v[214:215], v[214:215]
    v_pk_fma_f32 v[104:105], v[104:105], v[12:13], v[12:13] op_sel:[0,1,0] op_sel_hi:[1,1,0]
    v_pk_fma_f32 v[106:107], v[106:107], v[12:13], v[12:13] op_sel:[0,1,0] op_sel_hi:[1,1,0]
    v_pk_fma_f32 v[108:109], v[108:109], v[12:13], v[12:13] op_sel:[0,1,0] op_sel_hi:[1,1,0]
    v_pk_fma_f32 v[110:111], v[110:111], v[12:13], v[12:13] op_sel:[0,1,0] op_sel_hi:[1,1,0]
    v_pk_mul_f32 v[104:105], v[104:105], v[208:209]
    v_pk_mul_f32 v[106:107], v[106:107], v[210:211]
    v_pk_mul_f32 v[108:109], v[108:109], v[212:213]
    v_pk_mul_f32 v[110:111], v[110:111], v[214:215]
    v_exp_f32 v104, v104
    v_exp_f32 v105, v105
    v_exp_f32 v106, v106
    v_exp_f32 v107, v107
    v_exp_f32 v108, v108
    v_exp_f32 v109, v109
    v_exp_f32 v110, v110
    v_exp_f32 v111, v111
    v_pk_mul_f32 v[208:209], v[208:209], v[216:217]
    v_pk_mul_f32 v[210:211], v[210:211], v[218:219]
    v_pk_mul_f32 v[212:213], v[212:213], v[220:221]
    v_pk_mul_f32 v[214:215], v[214:215], v[222:223]
    v_pk_fma_f32 v[104:105], v[104:105], v[18:19], v[18:19] op_sel:[0,0,0] op_sel_hi:[1,0,0]
    v_pk_fma_f32 v[106:107], v[106:107], v[18:19], v[18:19] op_sel:[0,0,0] op_sel_hi:[1,0,0]
    v_pk_fma_f32 v[108:109], v[108:109], v[18:19], v[18:19] op_sel:[0,0,0] op_sel_hi:[1,0,0]
    v_pk_fma_f32 v[110:111], v[110:111], v[18:19], v[18:19] op_sel:[0,0,0] op_sel_hi:[1,0,0]
    v_rcp_f32 v104, v104
    v_rcp_f32 v105, v105
    v_rcp_f32 v106, v106
    v_rcp_f32 v107, v107
    v_rcp_f32 v108, v108
    v_rcp_f32 v109, v109
    v_rcp_f32 v110, v110
    v_rcp_f32 v111, v111
    v_pk_mul_f32 v[208:209], v[208:209], v[104:105]
    v_pk_mul_f32 v[210:211], v[210:211], v[106:107]
    v_pk_mul_f32 v[212:213], v[212:213], v[108:109]
    v_pk_mul_f32 v[214:215], v[214:215], v[110:111]
    v_cvt_pk_bf16_f32 v216, v208, v209
    v_cvt_pk_bf16_f32 v217, v210, v211
    v_cvt_pk_bf16_f32 v218, v212, v213
    v_cvt_pk_bf16_f32 v219, v214, v215
    buffer_store_dwordx4 v[216:219], v2, s[16:19], s49 offen offset:1024 sc1
    v_pk_mul_f32 v[96:97], v[224:225], v[224:225]
    v_pk_mul_f32 v[98:99], v[226:227], v[226:227]
    v_pk_mul_f32 v[100:101], v[228:229], v[228:229]
    v_pk_mul_f32 v[102:103], v[230:231], v[230:231]
    v_pk_fma_f32 v[96:97], v[96:97], v[14:15], v[14:15] op_sel:[0,1,0] op_sel_hi:[1,1,0]
    v_pk_fma_f32 v[98:99], v[98:99], v[14:15], v[14:15] op_sel:[0,1,0] op_sel_hi:[1,1,0]
    v_pk_fma_f32 v[100:101], v[100:101], v[14:15], v[14:15] op_sel:[0,1,0] op_sel_hi:[1,1,0]
    v_pk_fma_f32 v[102:103], v[102:103], v[14:15], v[14:15] op_sel:[0,1,0] op_sel_hi:[1,1,0]
    v_pk_mul_f32 v[96:97], v[96:97], v[224:225]
    v_pk_mul_f32 v[98:99], v[98:99], v[226:227]
    v_pk_mul_f32 v[100:101], v[100:101], v[228:229]
    v_pk_mul_f32 v[102:103], v[102:103], v[230:231]
    v_exp_f32 v96, v96
    v_exp_f32 v97, v97
    v_exp_f32 v98, v98
    v_exp_f32 v99, v99
    v_exp_f32 v100, v100
    v_exp_f32 v101, v101
    v_exp_f32 v102, v102
    v_exp_f32 v103, v103
    v_pk_mul_f32 v[224:225], v[224:225], v[232:233]
    v_pk_mul_f32 v[226:227], v[226:227], v[234:235]
    v_pk_mul_f32 v[228:229], v[228:229], v[236:237]
    v_pk_mul_f32 v[230:231], v[230:231], v[238:239]
    v_pk_fma_f32 v[96:97], v[96:97], v[18:19], v[18:19] op_sel:[0,1,1] op_sel_hi:[1,1,1]
    v_pk_fma_f32 v[98:99], v[98:99], v[18:19], v[18:19] op_sel:[0,1,1] op_sel_hi:[1,1,1]
    v_pk_fma_f32 v[100:101], v[100:101], v[18:19], v[18:19] op_sel:[0,1,1] op_sel_hi:[1,1,1]
    v_pk_fma_f32 v[102:103], v[102:103], v[18:19], v[18:19] op_sel:[0,1,1] op_sel_hi:[1,1,1]
    v_rcp_f32 v96, v96
    v_rcp_f32 v97, v97
    v_rcp_f32 v98, v98
    v_rcp_f32 v99, v99
    v_rcp_f32 v100, v100
    v_rcp_f32 v101, v101
    v_rcp_f32 v102, v102
    v_rcp_f32 v103, v103
    v_pk_mul_f32 v[224:225], v[224:225], v[96:97]
    v_pk_mul_f32 v[226:227], v[226:227], v[98:99]
    v_pk_mul_f32 v[228:229], v[228:229], v[100:101]
    v_pk_mul_f32 v[230:231], v[230:231], v[102:103]
    v_cvt_pk_bf16_f32 v232, v224, v225
    v_cvt_pk_bf16_f32 v233, v226, v227
    v_cvt_pk_bf16_f32 v234, v228, v229
    v_cvt_pk_bf16_f32 v235, v230, v231
    buffer_store_dwordx4 v[232:235], v32, s[16:19], s49 offen offset:0 sc1
    v_pk_mul_f32 v[104:105], v[240:241], v[240:241]
    v_pk_mul_f32 v[106:107], v[242:243], v[242:243]
    v_pk_mul_f32 v[108:109], v[244:245], v[244:245]
    v_pk_mul_f32 v[110:111], v[246:247], v[246:247]
    v_pk_fma_f32 v[104:105], v[104:105], v[14:15], v[14:15] op_sel:[0,1,0] op_sel_hi:[1,1,0]
    v_pk_fma_f32 v[106:107], v[106:107], v[14:15], v[14:15] op_sel:[0,1,0] op_sel_hi:[1,1,0]
    v_pk_fma_f32 v[108:109], v[108:109], v[14:15], v[14:15] op_sel:[0,1,0] op_sel_hi:[1,1,0]
    v_pk_fma_f32 v[110:111], v[110:111], v[14:15], v[14:15] op_sel:[0,1,0] op_sel_hi:[1,1,0]
    v_pk_mul_f32 v[104:105], v[104:105], v[240:241]
    v_pk_mul_f32 v[106:107], v[106:107], v[242:243]
    v_pk_mul_f32 v[108:109], v[108:109], v[244:245]
    v_pk_mul_f32 v[110:111], v[110:111], v[246:247]
    v_exp_f32 v104, v104
    v_exp_f32 v105, v105
    v_exp_f32 v106, v106
    v_exp_f32 v107, v107
    v_exp_f32 v108, v108
    v_exp_f32 v109, v109
    v_exp_f32 v110, v110
    v_exp_f32 v111, v111
    v_pk_mul_f32 v[240:241], v[240:241], v[248:249]
    v_pk_mul_f32 v[242:243], v[242:243], v[250:251]
    v_pk_mul_f32 v[244:245], v[244:245], v[252:253]
    v_pk_mul_f32 v[246:247], v[246:247], v[254:255]
    v_pk_fma_f32 v[104:105], v[104:105], v[18:19], v[18:19] op_sel:[0,1,1] op_sel_hi:[1,1,1]
    v_pk_fma_f32 v[106:107], v[106:107], v[18:19], v[18:19] op_sel:[0,1,1] op_sel_hi:[1,1,1]
    v_pk_fma_f32 v[108:109], v[108:109], v[18:19], v[18:19] op_sel:[0,1,1] op_sel_hi:[1,1,1]
L_pad3:
    s_cbranch_execz L_return
    v_pk_fma_f32 v[110:111], v[110:111], v[18:19], v[18:19] op_sel:[0,1,1] op_sel_hi:[1,1,1]
    v_rcp_f32 v104, v104
    v_rcp_f32 v105, v105
    v_rcp_f32 v106, v106
    v_rcp_f32 v107, v107
    v_rcp_f32 v108, v108
    v_rcp_f32 v109, v109
    v_rcp_f32 v110, v110
    v_rcp_f32 v111, v111
    s_waitcnt vmcnt(11)
    s_barrier
    ds_read_b128 v[160:163], v55 offset:0
    ds_read_b128 v[128:131], v54 offset:3584
    ds_read_b128 v[132:135], v54 offset:3072
    ds_read_b128 v[136:139], v54 offset:2560
    ds_read_b128 v[140:143], v54 offset:2048
    v_pk_mul_f32 v[240:241], v[240:241], v[104:105]
    v_pk_mul_f32 v[242:243], v[242:243], v[106:107]
    v_pk_mul_f32 v[244:245], v[244:245], v[108:109]
    v_pk_mul_f32 v[246:247], v[246:247], v[110:111]
    v_cvt_pk_bf16_f32 v248, v240, v241
    v_cvt_pk_bf16_f32 v249, v242, v243
    v_cvt_pk_bf16_f32 v250, v244, v245
    v_cvt_pk_bf16_f32 v251, v246, v247
    buffer_store_dwordx4 v[248:251], v32, s[16:19], s49 offen offset:1024 sc1
    s_waitcnt vmcnt(4)
    s_mov_b32 s79, 1
    s_atomic_add s79, s[16:17], s56
L_join:
    s_waitcnt lgkmcnt(2)
    v_mfma_f32_16x16x32_bf16 v[64:67], v[128:131], v[160:163], 0
    ds_read_b128 v[144:147], v54 offset:1536
    v_mfma_f32_16x16x32_bf16 v[68:71], v[132:135], v[160:163], 0
    ds_read_b128 v[148:151], v54 offset:1024
    s_waitcnt lgkmcnt(2)
    v_mfma_f32_16x16x32_bf16 v[72:75], v[136:139], v[160:163], 0
    ds_read_b128 v[152:155], v54 offset:512
    v_mfma_f32_16x16x32_bf16 v[76:79], v[140:143], v[160:163], 0
    ds_read_b128 v[156:159], v54 offset:0
    s_waitcnt lgkmcnt(3)
    v_mfma_f32_16x16x32_bf16 v[80:83], v[144:147], v[160:163], 0
    ds_read_b128 v[164:167], v55 offset:512
    s_waitcnt vmcnt(26)
    s_waitcnt lgkmcnt(3)
    v_mfma_f32_16x16x32_bf16 v[84:87], v[148:151], v[160:163], 0
    ds_read_b64_tr_b16 a[96:97], v52 offset:49152
    ds_read_b64_tr_b16 a[98:99], v52 offset:51200
    s_waitcnt lgkmcnt(4)
    v_mfma_f32_16x16x32_bf16 v[88:91], v[152:155], v[160:163], 0
    ds_read_b64_tr_b16 a[100:101], v53 offset:49152
    ds_read_b64_tr_b16 a[102:103], v53 offset:51200
    s_waitcnt lgkmcnt(5)
    v_mfma_f32_16x16x32_bf16 v[92:95], v[156:159], v[160:163], 0
    ds_read_b128 v[168:171], v55 offset:1024
    ds_read_b128 v[172:175], v55 offset:1536
    s_waitcnt lgkmcnt(6)
    v_mfma_f32_16x16x32_bf16 v[68:71], v[128:131], v[164:167], v[68:71]
    ds_read_b128 v[176:179], v55 offset:2048
    ds_read_b128 v[180:183], v55 offset:2560
    v_mfma_f32_16x16x32_bf16 v[72:75], v[132:135], v[164:167], v[72:75]
    ds_read_b128 v[184:187], v55 offset:3072
    s_add_u32 m0, s61, 57344
    v_mfma_f32_16x16x32_bf16 v[76:79], v[136:139], v[164:167], v[76:79]
    buffer_load_dwordx4 v48, s[20:23], s52 offen offset:0 lds
    ds_read_b64_tr_b16 a[104:105], v62 offset:49152
    v_mfma_f32_16x16x32_bf16 v[80:83], v[140:143], v[164:167], v[80:83]
    ds_read_b64_tr_b16 a[106:107], v62 offset:51200
    ds_read_b64_tr_b16 a[108:109], v123 offset:49152
    v_mfma_f32_16x16x32_bf16 v[84:87], v[144:147], v[164:167], v[84:87]
    ds_read_b64_tr_b16 a[110:111], v123 offset:51200
    buffer_load_dwordx4 v49, s[20:23], s52 offen offset:1024 lds
    v_mfma_f32_16x16x32_bf16 v[88:91], v[148:151], v[164:167], v[88:91]
    ds_read_b128 v[188:191], v55 offset:3584
    ds_read_b128 a[192:195], v55 offset:64
    v_mfma_f32_16x16x32_bf16 v[92:95], v[152:155], v[164:167], v[92:95]
    ds_read_b128 a[160:163], v54 offset:3648
    ds_read_b128 a[164:167], v54 offset:3136
    s_waitcnt lgkmcnt(3)
    v_mfma_f32_16x16x32_bf16 v[72:75], v[128:131], v[168:171], v[72:75]
    ds_read_b128 a[168:171], v54 offset:2624
    ds_read_b128 a[172:175], v54 offset:2112
    v_mfma_f32_16x16x32_bf16 v[76:79], v[132:135], v[168:171], v[76:79]
    ds_read_b128 a[176:179], v54 offset:1600
    s_waitcnt vmcnt(24)
    v_mfma_f32_16x16x32_bf16 v[80:83], v[136:139], v[168:171], v[80:83]
    ds_read_b64_tr_b16 a[112:113], v52 offset:53248
    ds_read_b64_tr_b16 a[114:115], v52 offset:55296
    v_mfma_f32_16x16x32_bf16 v[84:87], v[140:143], v[168:171], v[84:87]
    ds_read_b64_tr_b16 a[116:117], v53 offset:53248
    ds_read_b64_tr_b16 a[118:119], v53 offset:55296
    v_mfma_f32_16x16x32_bf16 v[88:91], v[144:147], v[168:171], v[88:91]
    buffer_load_dwordx4 v50, s[20:23], s52 offen offset:2048 lds
    ds_read_b64_tr_b16 a[120:121], v62 offset:53248
    v_mfma_f32_16x16x32_bf16 v[92:95], v[148:151], v[168:171], v[92:95]
    ds_read_b64_tr_b16 a[122:123], v62 offset:55296
    ds_read_b64_tr_b16 a[124:125], v123 offset:53248
    v_mfma_f32_16x16x32_bf16 v[76:79], v[128:131], v[172:175], v[76:79]
    ds_read_b64_tr_b16 a[126:127], v123 offset:55296
    ds_read_b128 a[180:183], v54 offset:1088
    v_mfma_f32_16x16x32_bf16 v[80:83], v[132:135], v[172:175], v[80:83]
    buffer_load_dwordx4 v51, s[20:23], s52 offen offset:3072 lds
    s_lshr_b32 s52, s52, 5
    v_mfma_f32_16x16x32_bf16 v[84:87], v[136:139], v[172:175], v[84:87]
    ds_read_b128 a[184:187], v54 offset:576
    ds_read_b128 a[188:191], v54 offset:64
    v_mfma_f32_16x16x32_bf16 v[88:91], v[140:143], v[172:175], v[88:91]
    ds_read_b128 a[196:199], v55 offset:576
    ds_read_b128 a[200:203], v55 offset:1088
    v_mfma_f32_16x16x32_bf16 v[92:95], v[144:147], v[172:175], v[92:95]
    ds_read_b128 a[204:207], v55 offset:1600
    ds_read_b128 a[208:211], v55 offset:2112
    v_mfma_f32_16x16x32_bf16 v[80:83], v[128:131], v[176:179], v[80:83]
    ds_read_b128 a[212:215], v55 offset:2624
    ds_read_b128 a[216:219], v55 offset:3136
    v_mfma_f32_16x16x32_bf16 v[84:87], v[132:135], v[176:179], v[84:87]
    ds_read_b128 a[220:223], v55 offset:3648
    ds_read_b32 v0, v61
    v_mfma_f32_16x16x32_bf16 v[88:91], v[136:139], v[176:179], v[88:91]
    s_add_u32 m0, s61, 0
    v_add_u32 v6, s74, v2
    v_mfma_f32_16x16x32_bf16 v[92:95], v[140:143], v[176:179], v[92:95]
    buffer_load_dwordx4 v48, s[20:23], s53 offen offset:0 lds
    buffer_load_dwordx4 v49, s[20:23], s53 offen offset:1024 lds
    v_mfma_f32_16x16x32_bf16 v[84:87], v[128:131], v[180:183], v[84:87]
    buffer_load_dwordx4 v50, s[20:23], s53 offen offset:2048 lds
    v_add_u32 v7, s75, v2
    v_mfma_f32_16x16x32_bf16 v[88:91], v[132:135], v[180:183], v[88:91]
    buffer_load_dwordx4 v51, s[20:23], s53 offen offset:3072 lds
    s_lshr_b32 s53, s53, 5
    v_mfma_f32_16x16x32_bf16 v[92:95], v[136:139], v[180:183], v[92:95]
    s_add_u32 m0, s61, 4096
    v_mfma_f32_16x16x32_bf16 v[88:91], v[128:131], v[184:187], v[88:91]
    buffer_load_dwordx4 v48, s[20:23], s54 offen offset:0 lds
    v_mfma_f32_16x16x32_bf16 v[92:95], v[132:135], v[184:187], v[92:95]
    v_mfma_f32_16x16x32_bf16 v[92:95], v[128:131], v[188:191], v[92:95]
    buffer_load_dwordx4 v49, s[20:23], s54 offen offset:1024 lds
    s_waitcnt lgkmcnt(1)
    v_mfma_f32_16x16x32_bf16 v[64:67], a[160:163], a[192:195], v[64:67]
    ds_read_b128 v[160:163], v55 offset:128
    s_waitcnt vmcnt(6)
    v_mfma_f32_16x16x32_bf16 v[68:71], a[164:167], a[192:195], v[68:71]
    ds_read_b64_tr_b16 a[128:129], v52 offset:57344
    ds_read_b64_tr_b16 a[130:131], v52 offset:59392
    v_mfma_f32_16x16x32_bf16 v[72:75], a[168:171], a[192:195], v[72:75]
    ds_read_b128 v[128:131], v54 offset:3712
    ds_read_b64_tr_b16 a[132:133], v53 offset:57344
    v_mfma_f32_16x16x32_bf16 v[76:79], a[172:175], a[192:195], v[76:79]
    ds_read_b64_tr_b16 a[134:135], v53 offset:59392
    buffer_load_dwordx4 v50, s[20:23], s54 offen offset:2048 lds
    v_mfma_f32_16x16x32_bf16 v[80:83], a[176:179], a[192:195], v[80:83]
    ds_read_b128 v[132:135], v54 offset:3200
    ds_read_b64_tr_b16 a[136:137], v62 offset:57344
    v_mfma_f32_16x16x32_bf16 v[84:87], a[180:183], a[192:195], v[84:87]
    ds_read_b64_tr_b16 a[138:139], v62 offset:59392
    ds_read_b128 v[136:139], v54 offset:2688
    v_mfma_f32_16x16x32_bf16 v[88:91], a[184:187], a[192:195], v[88:91]
    ds_read_b64_tr_b16 a[140:141], v123 offset:57344
    ds_read_b64_tr_b16 a[142:143], v123 offset:59392
    v_mfma_f32_16x16x32_bf16 v[92:95], a[188:191], a[192:195], v[92:95]
    ds_read_b128 v[140:143], v54 offset:2176
    ds_read_b128 v[144:147], v54 offset:1664
    v_mfma_f32_16x16x32_bf16 v[68:71], a[160:163], a[196:199], v[68:71]
    buffer_load_dwordx4 v51, s[20:23], s54 offen offset:3072 lds
    s_lshr_b32 s54, s54, 5
    v_mfma_f32_16x16x32_bf16 v[72:75], a[164:167], a[196:199], v[72:75]
    ds_read_b128 v[148:151], v54 offset:1152
    s_add_u32 m0, s61, 8192
    v_mfma_f32_16x16x32_bf16 v[76:79], a[168:171], a[196:199], v[76:79]
    buffer_load_dwordx4 v48, s[20:23], s55 offen offset:0 lds
    ds_read_b128 v[152:155], v54 offset:640
    v_mfma_f32_16x16x32_bf16 v[80:83], a[172:175], a[196:199], v[80:83]
    s_waitcnt vmcnt(13)
    s_mov_b32 s82, 256
    s_atomic_add s82, s[16:17], s56
    v_mfma_f32_16x16x32_bf16 v[84:87], a[176:179], a[196:199], v[84:87]
    ds_read_b128 v[156:159], v54 offset:128
    v_mfma_f32_16x16x32_bf16 v[88:91], a[180:183], a[196:199], v[88:91]
    buffer_load_dwordx4 v49, s[20:23], s55 offen offset:1024 lds
    s_waitcnt vmcnt(6)
    v_mfma_f32_16x16x32_bf16 v[92:95], a[184:187], a[196:199], v[92:95]
    ds_read_b128 v[164:167], v55 offset:640
    ds_read_b64_tr_b16 a[144:145], v52 offset:0
    v_mfma_f32_16x16x32_bf16 v[72:75], a[160:163], a[200:203], v[72:75]
    ds_read_b64_tr_b16 a[146:147], v52 offset:2048
    ds_read_b64_tr_b16 a[148:149], v53 offset:0
    v_mfma_f32_16x16x32_bf16 v[76:79], a[164:167], a[200:203], v[76:79]
    ds_read_b128 v[168:171], v55 offset:1152
    ds_read_b64_tr_b16 a[150:151], v53 offset:2048
    v_mfma_f32_16x16x32_bf16 v[80:83], a[168:171], a[200:203], v[80:83]
    buffer_load_dwordx4 v50, s[20:23], s55 offen offset:2048 lds
    ds_read_b64_tr_b16 a[152:153], v62 offset:0
    v_mfma_f32_16x16x32_bf16 v[84:87], a[172:175], a[200:203], v[84:87]
    ds_read_b128 v[172:175], v55 offset:1664
    ds_read_b64_tr_b16 a[154:155], v62 offset:2048
    v_mfma_f32_16x16x32_bf16 v[88:91], a[176:179], a[200:203], v[88:91]
    ds_read_b64_tr_b16 a[156:157], v123 offset:0
    ds_read_b128 v[176:179], v55 offset:2176
    v_mfma_f32_16x16x32_bf16 v[92:95], a[180:183], a[200:203], v[92:95]
    ds_read_b64_tr_b16 a[158:159], v123 offset:2048
    ds_read_b128 v[180:183], v55 offset:2688
    v_mfma_f32_16x16x32_bf16 v[76:79], a[160:163], a[204:207], v[76:79]
    buffer_load_dwordx4 v51, s[20:23], s55 offen offset:3072 lds
    s_lshr_b32 s55, s55, 5
    v_mfma_f32_16x16x32_bf16 v[80:83], a[164:167], a[204:207], v[80:83]
    ds_read_b128 v[184:187], v55 offset:3200
    s_waitcnt lgkmcnt(14)
    v_mfma_f32_16x16x32_bf16 v[84:87], a[168:171], a[204:207], v[84:87]
    ds_read_b128 v[188:191], v55 offset:3712
    s_add_u32 m0, s61, 49152
    v_mfma_f32_16x16x32_bf16 v[88:91], a[172:175], a[204:207], v[88:91]
    buffer_load_dwordx4 v48, s[20:23], s80 offen offset:0 lds
    ds_read_b32 v0, v61
    v_mfma_f32_16x16x32_bf16 v[92:95], a[176:179], a[204:207], v[92:95]
    v_mfma_f32_16x16x32_bf16 v[80:83], a[160:163], a[208:211], v[80:83]
    buffer_load_dwordx4 v49, s[20:23], s80 offen offset:1024 lds
    ds_read_b32 v0, v61
    v_mfma_f32_16x16x32_bf16 v[84:87], a[164:167], a[208:211], v[84:87]
    s_mov_b32 s83, 0
    s_atomic_add s83, s[16:17], s58 glc
    v_mfma_f32_16x16x32_bf16 v[88:91], a[168:171], a[208:211], v[88:91]
    v_mfma_f32_16x16x32_bf16 v[92:95], a[172:175], a[208:211], v[92:95]
    buffer_load_dwordx4 v50, s[20:23], s80 offen offset:2048 lds
    v_mfma_f32_16x16x32_bf16 v[84:87], a[160:163], a[212:215], v[84:87]
    v_mfma_f32_16x16x32_bf16 v[88:91], a[164:167], a[212:215], v[88:91]
    v_mfma_f32_16x16x32_bf16 v[92:95], a[168:171], a[212:215], v[92:95]
    v_mfma_f32_16x16x32_bf16 v[88:91], a[160:163], a[216:219], v[88:91]
    buffer_load_dwordx4 v51, s[20:23], s80 offen offset:3072 lds
    s_lshr_b32 s80, s80, 5
    v_mfma_f32_16x16x32_bf16 v[92:95], a[164:167], a[216:219], v[92:95]
    s_waitcnt lgkmcnt(14)
    v_mfma_f32_16x16x32_bf16 v[92:95], a[160:163], a[220:223], v[92:95]
    s_add_u32 m0, s61, 53248
    s_waitcnt lgkmcnt(2)
    v_mfma_f32_16x16x32_bf16 v[64:67], v[128:131], v[160:163], v[64:67]
    ds_read_b128 a[192:195], v55 offset:192
    buffer_load_dwordx4 v48, s[20:23], s81 offen offset:0 lds
    v_mfma_f32_16x16x32_bf16 v[68:71], v[132:135], v[160:163], v[68:71]
    ds_read_b128 a[160:163], v54 offset:3776
    v_mfma_f32_16x16x32_bf16 v[72:75], v[136:139], v[160:163], v[72:75]
    v_mfma_f32_16x16x32_bf16 v[76:79], v[140:143], v[160:163], v[76:79]
    ds_read_b128 a[164:167], v54 offset:3264
    buffer_load_dwordx4 v49, s[20:23], s81 offen offset:1024 lds
    v_mfma_f32_16x16x32_bf16 v[80:83], v[144:147], v[160:163], v[80:83]
    ds_read_b128 a[168:171], v54 offset:2752
    v_mfma_f32_16x16x32_bf16 v[84:87], v[148:151], v[160:163], v[84:87]
    v_mfma_f32_16x16x32_bf16 v[88:91], v[152:155], v[160:163], v[88:91]
    ds_read_b128 a[172:175], v54 offset:2240
    v_mfma_f32_16x16x32_bf16 v[92:95], v[156:159], v[160:163], v[92:95]
    buffer_load_dwordx4 v50, s[20:23], s81 offen offset:2048 lds
    v_mfma_f32_16x16x32_bf16 v[68:71], v[128:131], v[164:167], v[68:71]
    ds_read_b128 a[176:179], v54 offset:1728
    v_mfma_f32_16x16x32_bf16 v[72:75], v[132:135], v[164:167], v[72:75]
    ds_read_b128 a[180:183], v54 offset:1216
    v_mfma_f32_16x16x32_bf16 v[76:79], v[136:139], v[164:167], v[76:79]
    buffer_load_dwordx4 v51, s[20:23], s81 offen offset:3072 lds
    s_lshr_b32 s81, s81, 5
    v_mfma_f32_16x16x32_bf16 v[80:83], v[140:143], v[164:167], v[80:83]
    ds_read_b128 a[184:187], v54 offset:704
    v_mfma_f32_16x16x32_bf16 v[84:87], v[144:147], v[164:167], v[84:87]
    v_mfma_f32_16x16x32_bf16 v[88:91], v[148:151], v[164:167], v[88:91]
    ds_read_b128 a[188:191], v54 offset:192
    v_mfma_f32_16x16x32_bf16 v[92:95], v[152:155], v[164:167], v[92:95]
    ds_read_b128 a[196:199], v55 offset:704
    v_mfma_f32_16x16x32_bf16 v[72:75], v[128:131], v[168:171], v[72:75]
    v_mfma_f32_16x16x32_bf16 v[76:79], v[132:135], v[168:171], v[76:79]
    ds_read_b128 a[200:203], v55 offset:1216
    v_mfma_f32_16x16x32_bf16 v[80:83], v[136:139], v[168:171], v[80:83]
    v_mfma_f32_16x16x32_bf16 v[84:87], v[140:143], v[168:171], v[84:87]
    ds_read_b128 a[204:207], v55 offset:1728
    v_mfma_f32_16x16x32_bf16 v[88:91], v[144:147], v[168:171], v[88:91]
    ds_read_b128 a[208:211], v55 offset:2240
    v_mfma_f32_16x16x32_bf16 v[92:95], v[148:151], v[168:171], v[92:95]
    v_mfma_f32_16x16x32_bf16 v[76:79], v[128:131], v[172:175], v[76:79]
    ds_read_b128 a[212:215], v55 offset:2752
    v_mfma_f32_16x16x32_bf16 v[80:83], v[132:135], v[172:175], v[80:83]
    v_mfma_f32_16x16x32_bf16 v[84:87], v[136:139], v[172:175], v[84:87]
    ds_read_b128 a[216:219], v55 offset:3264
    s_waitcnt lgkmcnt(0)
    s_and_b32 s83, s83, 255
    s_cmp_ge_u32 s83, 7
    s_cbranch_scc0 L_slow_18
L_back_19:
    v_mfma_f32_16x16x32_bf16 v[88:91], v[140:143], v[172:175], v[88:91]
    ds_read_b128 a[220:223], v55 offset:3776
    v_mfma_f32_16x16x32_bf16 v[92:95], v[144:147], v[172:175], v[92:95]
    buffer_load_dwordx4 v[192:195], v6, s[16:19], s62 offen sc1
    v_mfma_f32_16x16x32_bf16 v[80:83], v[128:131], v[176:179], v[80:83]
    ds_read_b32 v0, v61
    v_mfma_f32_16x16x32_bf16 v[84:87], v[132:135], v[176:179], v[84:87]
    v_mfma_f32_16x16x32_bf16 v[88:91], v[136:139], v[176:179], v[88:91]
    buffer_load_dwordx4 v[196:199], v7, s[16:19], s62 offen sc1
    v_mfma_f32_16x16x32_bf16 v[92:95], v[140:143], v[176:179], v[92:95]
    v_mfma_f32_16x16x32_bf16 v[84:87], v[128:131], v[180:183], v[84:87]
    v_mfma_f32_16x16x32_bf16 v[88:91], v[132:135], v[180:183], v[88:91]
    buffer_load_dwordx4 v[200:203], v6, s[16:19], s0 offen sc1
    v_mfma_f32_16x16x32_bf16 v[92:95], v[136:139], v[180:183], v[92:95]
    v_mfma_f32_16x16x32_bf16 v[88:91], v[128:131], v[184:187], v[88:91]
    v_mfma_f32_16x16x32_bf16 v[92:95], v[132:135], v[184:187], v[92:95]
    buffer_load_dwordx4 v[204:207], v7, s[16:19], s0 offen sc1
    v_mfma_f32_16x16x32_bf16 v[92:95], v[128:131], v[188:191], v[92:95]
    s_waitcnt lgkmcnt(1)
    v_mfma_f32_16x16x32_bf16 v[64:67], a[160:163], a[192:195], v[64:67]
    ds_read_b128 v[96:99], v60 offset:1536
    v_mfma_f32_16x16x32_bf16 v[68:71], a[164:167], a[192:195], v[68:71]
    ds_read_b128 v[100:103], v60 offset:1024
    v_mfma_f32_16x16x32_bf16 v[72:75], a[168:171], a[192:195], v[72:75]
    buffer_load_dwordx4 v[208:211], v6, s[16:19], s1 offen sc1
    ds_read_b128 v[104:107], v60 offset:512
    v_mfma_f32_16x16x32_bf16 v[76:79], a[172:175], a[192:195], v[76:79]
    ds_read_b128 v[108:111], v60 offset:0
    v_mfma_f32_16x16x32_bf16 v[80:83], a[176:179], a[192:195], v[80:83]
    v_mfma_f32_16x16x32_bf16 v[84:87], a[180:183], a[192:195], v[84:87]
    buffer_load_dwordx4 v[212:215], v7, s[16:19], s1 offen sc1
    v_mfma_f32_16x16x32_bf16 v[88:91], a[184:187], a[192:195], v[88:91]
    v_mfma_f32_16x16x32_bf16 v[92:95], a[188:191], a[192:195], v[92:95]
    v_mfma_f32_16x16x32_bf16 v[68:71], a[160:163], a[196:199], v[68:71]
    buffer_load_dwordx4 v[216:219], v6, s[16:19], s3 offen sc1
    v_mfma_f32_16x16x32_bf16 v[72:75], a[164:167], a[196:199], v[72:75]
    v_mfma_f32_16x16x32_bf16 v[76:79], a[168:171], a[196:199], v[76:79]
    v_mfma_f32_16x16x32_bf16 v[80:83], a[172:175], a[196:199], v[80:83]
    buffer_load_dwordx4 v[220:223], v7, s[16:19], s3 offen sc1
    v_mfma_f32_16x16x32_bf16 v[84:87], a[176:179], a[196:199], v[84:87]
    s_waitcnt lgkmcnt(0)
    v_mfma_f32_16x16x32_bf16 v[88:91], a[180:183], a[196:199], v[88:91]
    v_lshlrev_b32 v63, 16, v63
    v_mfma_f32_16x16x32_bf16 v[92:95], a[184:187], a[196:199], v[92:95]
    buffer_load_dwordx4 v[224:227], v6, s[16:19], s39 offen sc1
    v_perm_b32 v8, v99, v99, v37
    v_mfma_f32_16x16x32_bf16 v[72:75], a[160:163], a[200:203], v[72:75]
    v_perm_b32 v9, v98, v98, v37
    v_mfma_f32_16x16x32_bf16 v[76:79], a[164:167], a[200:203], v[76:79]
    v_perm_b32 v10, v97, v97, v37
    v_mfma_f32_16x16x32_bf16 v[80:83], a[168:171], a[200:203], v[80:83]
    buffer_load_dwordx4 v[228:231], v7, s[16:19], s39 offen sc1
    v_perm_b32 v11, v96, v96, v37
    v_mfma_f32_16x16x32_bf16 v[84:87], a[172:175], a[200:203], v[84:87]
    v_perm_b32 v12, v103, v103, v37
    v_mfma_f32_16x16x32_bf16 v[88:91], a[176:179], a[200:203], v[88:91]
    v_perm_b32 v13, v102, v102, v37
    v_mfma_f32_16x16x32_bf16 v[92:95], a[180:183], a[200:203], v[92:95]
    buffer_load_dwordx4 v[232:235], v6, s[16:19], s40 offen sc1
    v_perm_b32 v14, v101, v101, v37
    v_mfma_f32_16x16x32_bf16 v[76:79], a[160:163], a[204:207], v[76:79]
    v_mfma_f32_16x16x32_bf16 v[80:83], a[164:167], a[204:207], v[80:83]
    v_perm_b32 v15, v100, v100, v37
    v_mfma_f32_16x16x32_bf16 v[84:87], a[168:171], a[204:207], v[84:87]
    v_perm_b32 v16, v107, v107, v37
    v_mfma_f32_16x16x32_bf16 v[88:91], a[172:175], a[204:207], v[88:91]
    buffer_load_dwordx4 v[236:239], v7, s[16:19], s40 offen sc1
    v_perm_b32 v17, v106, v106, v37
    v_mfma_f32_16x16x32_bf16 v[92:95], a[176:179], a[204:207], v[92:95]
    v_perm_b32 v18, v105, v105, v37
    v_mfma_f32_16x16x32_bf16 v[80:83], a[160:163], a[208:211], v[80:83]
    v_perm_b32 v19, v104, v104, v37
    v_mfma_f32_16x16x32_bf16 v[84:87], a[164:167], a[208:211], v[84:87]
    buffer_load_dwordx4 v[240:243], v6, s[16:19], s50 offen sc1
    v_perm_b32 v20, v111, v111, v37
    v_mfma_f32_16x16x32_bf16 v[88:91], a[168:171], a[208:211], v[88:91]
    v_perm_b32 v21, v110, v110, v37
    v_mfma_f32_16x16x32_bf16 v[92:95], a[172:175], a[208:211], v[92:95]
    v_perm_b32 v22, v109, v109, v37
    v_mfma_f32_16x16x32_bf16 v[84:87], a[160:163], a[212:215], v[84:87]
    buffer_load_dwordx4 v[244:247], v7, s[16:19], s50 offen sc1
    v_perm_b32 v23, v108, v108, v37
    v_mfma_f32_16x16x32_bf16 v[88:91], a[164:167], a[212:215], v[88:91]
    v_mfma_f32_16x16x32_bf16 v[92:95], a[168:171], a[212:215], v[92:95]
    v_mfma_f32_16x16x32_bf16 v[88:91], a[160:163], a[216:219], v[88:91]
    buffer_load_dwordx4 v[248:251], v6, s[16:19], s51 offen sc1
    v_mfma_f32_16x16x32_bf16 v[92:95], a[164:167], a[216:219], v[92:95]
    v_mfma_f32_16x16x32_bf16 v[92:95], a[160:163], a[220:223], v[92:95]
    s_cmp_eq_u32 s77, 0
    s_cbranch_scc0 L_odd_20
    s_waitcnt vmcnt(14)
    v_mfma_f32_16x16x32_bf16 v[128:131], a[0:3], v[192:195], 0
    buffer_load_dwordx4 v[252:255], v7, s[16:19], s51 offen sc1
    s_mov_b32 s83, 0
    v_mfma_f32_16x16x32_bf16 v[132:135], a[4:7], v[192:195], 0
    s_atomic_add s83, s[16:17], s58 glc
    v_mfma_f32_16x16x32_bf16 v[136:139], a[8:11], v[192:195], 0
    s_waitcnt lgkmcnt(14)
    v_mfma_f32_16x16x32_bf16 v[140:143], a[12:15], v[192:195], 0
    s_waitcnt vmcnt(14)
    v_mfma_f32_16x16x32_bf16 v[144:147], a[0:3], v[196:199], 0
    buffer_load_dwordx4 v[192:195], v6, s[16:19], s52 offen sc1
    v_mfma_f32_16x16x32_bf16 v[148:151], a[4:7], v[196:199], 0
    ds_write_b128 v58, v[80:83] offset:0
    v_mfma_f32_16x16x32_bf16 v[152:155], a[8:11], v[196:199], 0
    v_fma_f32 v8, v8, v63, v64
    v_fma_f32 v9, v9, v63, v65
    v_mfma_f32_16x16x32_bf16 v[156:159], a[12:15], v[196:199], 0
    ds_write_b128 v58, v[84:87] offset:1024
    s_waitcnt vmcnt(14)
    v_mfma_f32_16x16x32_bf16 v[128:131], a[16:19], v[200:203], v[128:131]
    buffer_load_dwordx4 v[196:199], v7, s[16:19], s52 offen sc1
    v_fma_f32 v10, v10, v63, v66
    v_mfma_f32_16x16x32_bf16 v[132:135], a[20:23], v[200:203], v[132:135]
    v_fma_f32 v11, v11, v63, v67
    v_fma_f32 v12, v12, v63, v68
    v_mfma_f32_16x16x32_bf16 v[136:139], a[24:27], v[200:203], v[136:139]
    ds_write_b128 v58, v[88:91] offset:2048
    v_mfma_f32_16x16x32_bf16 v[140:143], a[28:31], v[200:203], v[140:143]
    v_fma_f32 v13, v13, v63, v69
    s_waitcnt vmcnt(14)
    v_mfma_f32_16x16x32_bf16 v[144:147], a[16:19], v[204:207], v[144:147]
    buffer_load_dwordx4 v[200:203], v6, s[16:19], s53 offen sc1
    v_fma_f32 v14, v14, v63, v70
    v_mfma_f32_16x16x32_bf16 v[148:151], a[20:23], v[204:207], v[148:151]
    ds_write_b128 v58, v[92:95] offset:3072
    v_mfma_f32_16x16x32_bf16 v[152:155], a[24:27], v[204:207], v[152:155]
    v_fma_f32 v15, v15, v63, v71
    v_fma_f32 v16, v16, v63, v72
    v_mfma_f32_16x16x32_bf16 v[156:159], a[28:31], v[204:207], v[156:159]
    ds_read_b32 v0, v61
    s_waitcnt vmcnt(14)
    v_mfma_f32_16x16x32_bf16 v[128:131], a[32:35], v[208:211], v[128:131]
    buffer_load_dwordx4 v[204:207], v7, s[16:19], s53 offen sc1
    v_fma_f32 v17, v17, v63, v73
    v_mfma_f32_16x16x32_bf16 v[132:135], a[36:39], v[208:211], v[132:135]
    v_fma_f32 v18, v18, v63, v74
    v_mfma_f32_16x16x32_bf16 v[136:139], a[40:43], v[208:211], v[136:139]
    v_fma_f32 v19, v19, v63, v75
    v_mfma_f32_16x16x32_bf16 v[140:143], a[44:47], v[208:211], v[140:143]
    v_fma_f32 v20, v20, v63, v76
    s_waitcnt vmcnt(14)
    v_mfma_f32_16x16x32_bf16 v[144:147], a[32:35], v[212:215], v[144:147]
    buffer_load_dwordx4 v[208:211], v6, s[16:19], s54 offen sc1
    v_fma_f32 v21, v21, v63, v77
    v_mfma_f32_16x16x32_bf16 v[148:151], a[36:39], v[212:215], v[148:151]
    v_fma_f32 v22, v22, v63, v78
    v_mfma_f32_16x16x32_bf16 v[152:155], a[40:43], v[212:215], v[152:155]
    v_fma_f32 v23, v23, v63, v79
    v_mfma_f32_16x16x32_bf16 v[156:159], a[44:47], v[212:215], v[156:159]
    s_branch L_join_21
L_odd_20:
    s_waitcnt vmcnt(14)
    v_mfma_f32_16x16x32_bf16 v[128:131], a[0:3], v[192:195], 0
    buffer_load_dwordx4 v[252:255], v7, s[16:19], s51 offen sc1
    s_mov_b32 s83, 0
    v_mfma_f32_16x16x32_bf16 v[132:135], a[4:7], v[192:195], 0
    s_atomic_add s83, s[16:17], s58 glc
    v_mfma_f32_16x16x32_bf16 v[136:139], a[8:11], v[192:195], 0
    s_waitcnt lgkmcnt(14)
    v_mfma_f32_16x16x32_bf16 v[140:143], a[12:15], v[192:195], 0
    s_waitcnt vmcnt(14)
    v_mfma_f32_16x16x32_bf16 v[144:147], a[0:3], v[196:199], 0
    buffer_load_dwordx4 v[192:195], v6, s[16:19], s52 offen sc1
    v_mfma_f32_16x16x32_bf16 v[148:151], a[4:7], v[196:199], 0
    ds_write_b128 v58, v[64:67] offset:0
    v_mfma_f32_16x16x32_bf16 v[152:155], a[8:11], v[196:199], 0
    v_fma_f32 v8, v8, v63, v80
    v_fma_f32 v9, v9, v63, v81
    v_mfma_f32_16x16x32_bf16 v[156:159], a[12:15], v[196:199], 0
    ds_write_b128 v58, v[68:71] offset:1024
    s_waitcnt vmcnt(14)
    v_mfma_f32_16x16x32_bf16 v[128:131], a[16:19], v[200:203], v[128:131]
    buffer_load_dwordx4 v[196:199], v7, s[16:19], s52 offen sc1
    v_fma_f32 v10, v10, v63, v82
    v_mfma_f32_16x16x32_bf16 v[132:135], a[20:23], v[200:203], v[132:135]
    v_fma_f32 v11, v11, v63, v83
    v_fma_f32 v12, v12, v63, v84
    v_mfma_f32_16x16x32_bf16 v[136:139], a[24:27], v[200:203], v[136:139]
    ds_write_b128 v58, v[72:75] offset:2048
    v_mfma_f32_16x16x32_bf16 v[140:143], a[28:31], v[200:203], v[140:143]
    v_fma_f32 v13, v13, v63, v85
    s_waitcnt vmcnt(14)
    v_mfma_f32_16x16x32_bf16 v[144:147], a[16:19], v[204:207], v[144:147]
    buffer_load_dwordx4 v[200:203], v6, s[16:19], s53 offen sc1
    v_fma_f32 v14, v14, v63, v86
    v_mfma_f32_16x16x32_bf16 v[148:151], a[20:23], v[204:207], v[148:151]
    ds_write_b128 v58, v[76:79] offset:3072
    v_mfma_f32_16x16x32_bf16 v[152:155], a[24:27], v[204:207], v[152:155]
    v_fma_f32 v15, v15, v63, v87
    v_fma_f32 v16, v16, v63, v88
    v_mfma_f32_16x16x32_bf16 v[156:159], a[28:31], v[204:207], v[156:159]
    ds_read_b32 v0, v61
    s_waitcnt vmcnt(14)
    v_mfma_f32_16x16x32_bf16 v[128:131], a[32:35], v[208:211], v[128:131]
    buffer_load_dwordx4 v[204:207], v7, s[16:19], s53 offen sc1
    v_fma_f32 v17, v17, v63, v89
    v_mfma_f32_16x16x32_bf16 v[132:135], a[36:39], v[208:211], v[132:135]
    v_fma_f32 v18, v18, v63, v90
    v_mfma_f32_16x16x32_bf16 v[136:139], a[40:43], v[208:211], v[136:139]
    v_fma_f32 v19, v19, v63, v91
    v_mfma_f32_16x16x32_bf16 v[140:143], a[44:47], v[208:211], v[140:143]
    v_fma_f32 v20, v20, v63, v92
    s_waitcnt vmcnt(14)
    v_mfma_f32_16x16x32_bf16 v[144:147], a[32:35], v[212:215], v[144:147]
    buffer_load_dwordx4 v[208:211], v6, s[16:19], s54 offen sc1
    v_fma_f32 v21, v21, v63, v93
    v_mfma_f32_16x16x32_bf16 v[148:151], a[36:39], v[212:215], v[148:151]
    v_fma_f32 v22, v22, v63, v94
    v_mfma_f32_16x16x32_bf16 v[152:155], a[40:43], v[212:215], v[152:155]
    v_fma_f32 v23, v23, v63, v95
    v_mfma_f32_16x16x32_bf16 v[156:159], a[44:47], v[212:215], v[156:159]
L_join_21:
    s_waitcnt vmcnt(14)
    v_mfma_f32_16x16x32_bf16 v[128:131], a[48:51], v[216:219], v[128:131]
    buffer_load_dwordx4 v[212:215], v7, s[16:19], s54 offen sc1
    v_mfma_f32_16x16x32_bf16 v[132:135], a[52:55], v[216:219], v[132:135]
    s_waitcnt lgkmcnt(1)
    s_barrier
    v_mfma_f32_16x16x32_bf16 v[136:139], a[56:59], v[216:219], v[136:139]
    ds_read_b128 v[96:99], v59 offset:0
    ds_read_b128 v[100:103], v59 offset:1024
    v_mfma_f32_16x16x32_bf16 v[140:143], a[60:63], v[216:219], v[140:143]
    ds_read_b128 v[104:107], v59 offset:2048
    s_waitcnt vmcnt(14)
    v_mfma_f32_16x16x32_bf16 v[144:147], a[48:51], v[220:223], v[144:147]
    ds_read_b128 v[108:111], v59 offset:3072
    buffer_load_dwordx4 v[216:219], v6, s[16:19], s55 offen sc1
    v_mfma_f32_16x16x32_bf16 v[148:151], a[52:55], v[220:223], v[148:151]
    ds_read_b32 v0, v61
    v_mfma_f32_16x16x32_bf16 v[152:155], a[56:59], v[220:223], v[152:155]
    v_mfma_f32_16x16x32_bf16 v[156:159], a[60:63], v[220:223], v[156:159]
    s_waitcnt vmcnt(14)
    v_mfma_f32_16x16x32_bf16 v[128:131], a[64:67], v[224:227], v[128:131]
    v_mfma_f32_16x16x32_bf16 v[132:135], a[68:71], v[224:227], v[132:135]
    buffer_load_dwordx4 v[220:223], v7, s[16:19], s55 offen sc1
    v_mfma_f32_16x16x32_bf16 v[136:139], a[72:75], v[224:227], v[136:139]
    s_waitcnt lgkmcnt(1)
    v_add_f32 v8, v8, v96
    v_mfma_f32_16x16x32_bf16 v[140:143], a[76:79], v[224:227], v[140:143]
    v_add_f32 v9, v9, v97
    s_waitcnt vmcnt(14)
    v_mfma_f32_16x16x32_bf16 v[144:147], a[64:67], v[228:231], v[144:147]
    v_add_f32 v10, v10, v98
    v_add_f32 v11, v11, v99
    v_mfma_f32_16x16x32_bf16 v[148:151], a[68:71], v[228:231], v[148:151]
    v_cvt_pk_bf16_f32 v24, v8, v9
    v_cvt_pk_bf16_f32 v25, v10, v11
    v_mfma_f32_16x16x32_bf16 v[152:155], a[72:75], v[228:231], v[152:155]
    buffer_store_dwordx2 v[24:25], v61, s[16:19], s67 offen offset:0 sc1
    buffer_load_dwordx4 v[224:227], v6, s[16:19], s80 offen sc1
    v_mfma_f32_16x16x32_bf16 v[156:159], a[76:79], v[228:231], v[156:159]
    v_add_f32 v12, v12, v100
    s_waitcnt vmcnt(15)
    v_mfma_f32_16x16x32_bf16 v[128:131], a[80:83], v[232:235], v[128:131]
    v_add_f32 v13, v13, v101
    v_add_f32 v14, v14, v102
    v_mfma_f32_16x16x32_bf16 v[132:135], a[84:87], v[232:235], v[132:135]
    v_add_f32 v15, v15, v103
    v_cvt_pk_bf16_f32 v26, v12, v13
    v_mfma_f32_16x16x32_bf16 v[136:139], a[88:91], v[232:235], v[136:139]
    v_cvt_pk_bf16_f32 v27, v14, v15
    v_mfma_f32_16x16x32_bf16 v[140:143], a[92:95], v[232:235], v[140:143]
    buffer_store_dwordx2 v[26:27], v61, s[16:19], s67 offen offset:512 sc1
    s_waitcnt vmcnt(15)
    v_mfma_f32_16x16x32_bf16 v[144:147], a[80:83], v[236:239], v[144:147]
    buffer_load_dwordx4 v[228:231], v7, s[16:19], s80 offen sc1
    v_add_f32 v16, v16, v104
    v_mfma_f32_16x16x32_bf16 v[148:151], a[84:87], v[236:239], v[148:151]
    v_add_f32 v17, v17, v105
    v_add_f32 v18, v18, v106
    v_mfma_f32_16x16x32_bf16 v[152:155], a[88:91], v[236:239], v[152:155]
    v_add_f32 v19, v19, v107
    v_cvt_pk_bf16_f32 v28, v16, v17
    v_mfma_f32_16x16x32_bf16 v[156:159], a[92:95], v[236:239], v[156:159]
    v_cvt_pk_bf16_f32 v29, v18, v19
L_pad4:
    s_cbranch_execz L_return
    s_waitcnt vmcnt(15)
    v_mfma_f32_16x16x32_bf16 v[128:131], a[96:99], v[240:243], v[128:131]
    buffer_store_dwordx2 v[28:29], v61, s[16:19], s67 offen offset:1024 sc1
    buffer_load_dwordx4 v[232:235], v6, s[16:19], s81 offen sc1
    v_mfma_f32_16x16x32_bf16 v[132:135], a[100:103], v[240:243], v[132:135]
    v_add_f32 v20, v20, v108
    v_add_f32 v21, v21, v109
    v_mfma_f32_16x16x32_bf16 v[136:139], a[104:107], v[240:243], v[136:139]
    v_add_u32 v6, 114688, v6
    v_add_f32 v22, v22, v110
    v_mfma_f32_16x16x32_bf16 v[140:143], a[108:111], v[240:243], v[140:143]
    v_add_f32 v23, v23, v111
    s_waitcnt vmcnt(16)
    v_mfma_f32_16x16x32_bf16 v[144:147], a[96:99], v[244:247], v[144:147]
    v_cvt_pk_bf16_f32 v30, v20, v21
    v_cvt_pk_bf16_f32 v31, v22, v23
    v_mfma_f32_16x16x32_bf16 v[148:151], a[100:103], v[244:247], v[148:151]
    buffer_store_dwordx2 v[30:31], v61, s[16:19], s67 offen offset:1536 sc1
    buffer_load_dwordx4 v[236:239], v7, s[16:19], s81 offen sc1
    v_mfma_f32_16x16x32_bf16 v[152:155], a[104:107], v[244:247], v[152:155]
    v_add_u32 v7, 114688, v7
    v_mfma_f32_16x16x32_bf16 v[156:159], a[108:111], v[244:247], v[156:159]
    s_waitcnt lgkmcnt(0)
    s_cmp_ge_u32 s83, 1792
    s_cbranch_scc0 L_slow_22
L_back_23:
    s_waitcnt vmcnt(17)
    v_mfma_f32_16x16x32_bf16 v[128:131], a[112:115], v[248:251], v[128:131]
    s_waitcnt vmcnt(32)
    v_mfma_f32_16x16x32_bf16 v[132:135], a[116:119], v[248:251], v[132:135]
    ds_read_b64_tr_b16 a[160:161], v52 offset:4096
    v_mfma_f32_16x16x32_bf16 v[136:139], a[120:123], v[248:251], v[136:139]
    buffer_load_dwordx4 v[240:243], v6, s[16:19], s62 offen sc1
    ds_read_b64_tr_b16 a[162:163], v52 offset:6144
    v_mfma_f32_16x16x32_bf16 v[140:143], a[124:127], v[248:251], v[140:143]
    ds_read_b64_tr_b16 a[164:165], v53 offset:4096
    s_waitcnt vmcnt(17)
    v_mfma_f32_16x16x32_bf16 v[144:147], a[112:115], v[252:255], v[144:147]
    ds_read_b64_tr_b16 a[166:167], v53 offset:6144
    v_mfma_f32_16x16x32_bf16 v[148:151], a[116:119], v[252:255], v[148:151]
    ds_read_b64_tr_b16 a[168:169], v62 offset:4096
    v_mfma_f32_16x16x32_bf16 v[152:155], a[120:123], v[252:255], v[152:155]
    ds_read_b64_tr_b16 a[170:171], v62 offset:6144
    v_mfma_f32_16x16x32_bf16 v[156:159], a[124:127], v[252:255], v[156:159]
    buffer_load_dwordx4 v[244:247], v6, s[16:19], s0 offen sc1
    s_waitcnt vmcnt(17)
    v_mfma_f32_16x16x32_bf16 v[128:131], a[128:131], v[192:195], v[128:131]
    ds_read_b64_tr_b16 a[172:173], v123 offset:4096
    ds_read_b64_tr_b16 a[174:175], v123 offset:6144
    v_mfma_f32_16x16x32_bf16 v[132:135], a[132:135], v[192:195], v[132:135]
    ds_read_b64_tr_b16 a[176:177], v52 offset:8192
    v_mfma_f32_16x16x32_bf16 v[136:139], a[136:139], v[192:195], v[136:139]
    ds_read_b64_tr_b16 a[178:179], v52 offset:10240
    v_mfma_f32_16x16x32_bf16 v[140:143], a[140:143], v[192:195], v[140:143]
    ds_read_b64_tr_b16 a[180:181], v53 offset:8192
    s_waitcnt vmcnt(16)
    v_mfma_f32_16x16x32_bf16 v[144:147], a[128:131], v[196:199], v[144:147]
    buffer_load_dwordx4 v[248:251], v6, s[16:19], s1 offen sc1
    ds_read_b64_tr_b16 a[182:183], v53 offset:10240
    v_mfma_f32_16x16x32_bf16 v[148:151], a[132:135], v[196:199], v[148:151]
    ds_read_b64_tr_b16 a[184:185], v62 offset:8192
    v_mfma_f32_16x16x32_bf16 v[152:155], a[136:139], v[196:199], v[152:155]
    ds_read_b64_tr_b16 a[186:187], v62 offset:10240
    v_mfma_f32_16x16x32_bf16 v[156:159], a[140:143], v[196:199], v[156:159]
    ds_read_b64_tr_b16 a[188:189], v123 offset:8192
    s_waitcnt vmcnt(16) lgkmcnt(14)
    v_mfma_f32_16x16x32_bf16 v[128:131], a[144:147], v[200:203], v[128:131]
    ds_read_b64_tr_b16 a[190:191], v123 offset:10240
    v_mfma_f32_16x16x32_bf16 v[132:135], a[148:151], v[200:203], v[132:135]
    buffer_load_dwordx4 v[252:255], v6, s[16:19], s3 offen sc1
    ds_read_b64_tr_b16 a[192:193], v52 offset:49152
    v_mfma_f32_16x16x32_bf16 v[136:139], a[152:155], v[200:203], v[136:139]
    ds_read_b64_tr_b16 a[194:195], v52 offset:51200
    v_mfma_f32_16x16x32_bf16 v[140:143], a[156:159], v[200:203], v[140:143]
    ds_read_b64_tr_b16 a[196:197], v53 offset:49152
    s_waitcnt vmcnt(16)
    v_mfma_f32_16x16x32_bf16 v[144:147], a[144:147], v[204:207], v[144:147]
    ds_read_b64_tr_b16 a[198:199], v53 offset:51200
    v_mfma_f32_16x16x32_bf16 v[148:151], a[148:151], v[204:207], v[148:151]
    ds_read_b64_tr_b16 a[200:201], v62 offset:49152
    v_mfma_f32_16x16x32_bf16 v[152:155], a[152:155], v[204:207], v[152:155]
    buffer_load_dwordx4 v[192:195], v6, s[16:19], s39 offen sc1
    ds_read_b64_tr_b16 a[202:203], v62 offset:51200
    v_mfma_f32_16x16x32_bf16 v[156:159], a[156:159], v[204:207], v[156:159]
    ds_read_b64_tr_b16 a[204:205], v123 offset:49152
    s_waitcnt vmcnt(16) lgkmcnt(14)
    v_mfma_f32_16x16x32_bf16 v[128:131], a[160:163], v[208:211], v[128:131]
    ds_read_b64_tr_b16 a[206:207], v123 offset:51200
    s_waitcnt vmcnt(62)
    v_mfma_f32_16x16x32_bf16 v[132:135], a[164:167], v[208:211], v[132:135]
    ds_read_b64_tr_b16 a[208:209], v52 offset:53248
    v_mfma_f32_16x16x32_bf16 v[136:139], a[168:171], v[208:211], v[136:139]
    ds_read_b64_tr_b16 a[210:211], v52 offset:55296
    v_mfma_f32_16x16x32_bf16 v[140:143], a[172:175], v[208:211], v[140:143]
    buffer_load_dwordx4 v[196:199], v6, s[16:19], s40 offen sc1
    s_waitcnt vmcnt(16)
    v_mfma_f32_16x16x32_bf16 v[144:147], a[160:163], v[212:215], v[144:147]
    ds_read_b64_tr_b16 a[212:213], v53 offset:53248
    ds_read_b64_tr_b16 a[214:215], v53 offset:55296
    v_mfma_f32_16x16x32_bf16 v[148:151], a[164:167], v[212:215], v[148:151]
    ds_read_b64_tr_b16 a[216:217], v62 offset:53248
    v_mfma_f32_16x16x32_bf16 v[152:155], a[168:171], v[212:215], v[152:155]
    ds_read_b64_tr_b16 a[218:219], v62 offset:55296
    v_mfma_f32_16x16x32_bf16 v[156:159], a[172:175], v[212:215], v[156:159]
    ds_read_b64_tr_b16 a[220:221], v123 offset:53248
    s_waitcnt vmcnt(15) lgkmcnt(14)
    v_mfma_f32_16x16x32_bf16 v[128:131], a[176:179], v[216:219], v[128:131]
    buffer_load_dwordx4 v[200:203], v6, s[16:19], s50 offen sc1
    ds_read_b64_tr_b16 a[222:223], v123 offset:55296
    v_mfma_f32_16x16x32_bf16 v[132:135], a[180:183], v[216:219], v[132:135]
    ds_read_b32 v0, v61
    v_mfma_f32_16x16x32_bf16 v[136:139], a[184:187], v[216:219], v[136:139]
    v_rcp_f32 v125, v125
    v_mfma_f32_16x16x32_bf16 v[140:143], a[188:191], v[216:219], v[140:143]
    v_lshlrev_b32 v8, 16, v40
    s_waitcnt vmcnt(15)
    v_mfma_f32_16x16x32_bf16 v[144:147], a[176:179], v[220:223], v[144:147]
    v_and_b32 v9, 0xffff0000, v40
    v_lshlrev_b32 v10, 16, v41
    v_mfma_f32_16x16x32_bf16 v[148:151], a[180:183], v[220:223], v[148:151]
    buffer_load_dwordx4 v[204:207], v6, s[16:19], s51 offen sc1
    v_and_b32 v11, 0xffff0000, v41
    v_mfma_f32_16x16x32_bf16 v[152:155], a[184:187], v[220:223], v[152:155]
    v_lshlrev_b32 v12, 16, v42
    v_and_b32 v13, 0xffff0000, v42
    v_mfma_f32_16x16x32_bf16 v[156:159], a[188:191], v[220:223], v[156:159]
    v_lshlrev_b32 v14, 16, v43
    s_waitcnt vmcnt(14) lgkmcnt(9)
    v_mfma_f32_16x16x32_bf16 v[128:131], a[192:195], v[224:227], v[128:131]
    v_and_b32 v15, 0xffff0000, v43
    v_mul_f32 v124, v124, v125
    v_mfma_f32_16x16x32_bf16 v[132:135], a[196:199], v[224:227], v[132:135]
    v_rcp_f32 v127, v127
    v_mfma_f32_16x16x32_bf16 v[136:139], a[200:203], v[224:227], v[136:139]
    buffer_load_dwordx4 v[208:211], v6, s[16:19], s52 offen sc1
    v_lshlrev_b32 v16, 16, v44
    v_mfma_f32_16x16x32_bf16 v[140:143], a[204:207], v[224:227], v[140:143]
    v_and_b32 v17, 0xffff0000, v44
    s_waitcnt vmcnt(13)
    v_mfma_f32_16x16x32_bf16 v[144:147], a[192:195], v[228:231], v[144:147]
    v_lshlrev_b32 v18, 16, v45
    v_and_b32 v19, 0xffff0000, v45
    v_mfma_f32_16x16x32_bf16 v[148:151], a[196:199], v[228:231], v[148:151]
    v_lshlrev_b32 v20, 16, v46
    v_and_b32 v21, 0xffff0000, v46
    v_mfma_f32_16x16x32_bf16 v[152:155], a[200:203], v[228:231], v[152:155]
    v_lshlrev_b32 v22, 16, v47
    v_and_b32 v23, 0xffff0000, v47
    v_mfma_f32_16x16x32_bf16 v[156:159], a[204:207], v[228:231], v[156:159]
    buffer_load_dwordx4 v[212:215], v6, s[16:19], s53 offen sc1
    s_waitcnt vmcnt(12) lgkmcnt(1)
    v_mfma_f32_16x16x32_bf16 v[128:131], a[208:211], v[232:235], v[128:131]
    v_mul_f32 v126, v126, v127
    v_fma_f32 v24, v8, v125, -v124
    v_mfma_f32_16x16x32_bf16 v[132:135], a[212:215], v[232:235], v[132:135]
    v_fma_f32 v25, v9, v125, -v124
    v_fma_f32 v26, v10, v125, -v124
    v_mfma_f32_16x16x32_bf16 v[136:139], a[216:219], v[232:235], v[136:139]
    v_fma_f32 v27, v11, v125, -v124
    s_waitcnt vmcnt(11)
    v_mfma_f32_16x16x32_bf16 v[140:143], a[220:223], v[232:235], v[140:143]
    v_fma_f32 v28, v12, v125, -v124
    s_waitcnt vmcnt(10)
    v_mfma_f32_16x16x32_bf16 v[144:147], a[208:211], v[236:239], v[144:147]
    buffer_load_dwordx4 v[216:219], v6, s[16:19], s54 offen sc1
    s_mov_b32 s79, 1
    v_mfma_f32_16x16x32_bf16 v[148:151], a[212:215], v[236:239], v[148:151]
    v_fma_f32 v29, v13, v125, -v124
    s_atomic_add s79, s[16:17], s57
    v_mfma_f32_16x16x32_bf16 v[152:155], a[216:219], v[236:239], v[152:155]
    v_fma_f32 v30, v14, v125, -v124
    v_fma_f32 v31, v15, v125, -v124
    v_mfma_f32_16x16x32_bf16 v[156:159], a[220:223], v[236:239], v[156:159]
    v_fma_f32 v32, v16, v127, -v126
    s_waitcnt vmcnt(10)
    v_mfma_f32_16x16x32_bf16 v[160:163], a[0:3], v[240:243], 0
    buffer_load_dwordx4 v[220:223], v6, s[16:19], s55 offen sc1
    v_fma_f32 v33, v17, v127, -v126
    v_mfma_f32_16x16x32_bf16 v[164:167], a[4:7], v[240:243], 0
    v_fma_f32 v34, v18, v127, -v126
    v_fma_f32 v35, v19, v127, -v126
    v_mfma_f32_16x16x32_bf16 v[168:171], a[8:11], v[240:243], 0
    v_fma_f32 v36, v20, v127, -v126
    v_fma_f32 v37, v21, v127, -v126
    v_mfma_f32_16x16x32_bf16 v[172:175], a[12:15], v[240:243], 0
    v_fma_f32 v38, v22, v127, -v126
    s_waitcnt vmcnt(10)
    v_mfma_f32_16x16x32_bf16 v[160:163], a[16:19], v[244:247], v[160:163]
    v_fma_f32 v39, v23, v127, -v126
    v_mov_b32 v96, 0
    v_mfma_f32_16x16x32_bf16 v[164:167], a[20:23], v[244:247], v[164:167]
    buffer_load_dwordx4 v[224:227], v6, s[16:19], s80 offen sc1
    v_mov_b32 v97, 0
    v_mfma_f32_16x16x32_bf16 v[168:171], a[24:27], v[244:247], v[168:171]
    v_mov_b32 v98, 0
    v_mov_b32 v99, 0
    v_mfma_f32_16x16x32_bf16 v[172:175], a[28:31], v[244:247], v[172:175]
    v_mov_b32 v100, 0
    s_waitcnt vmcnt(10)
    v_mfma_f32_16x16x32_bf16 v[160:163], a[32:35], v[248:251], v[160:163]
    v_mov_b32 v101, 0
    v_mov_b32 v102, 0
    v_mfma_f32_16x16x32_bf16 v[164:167], a[36:39], v[248:251], v[164:167]
    v_mov_b32 v103, 0
    v_mov_b32 v104, 0
    v_mfma_f32_16x16x32_bf16 v[168:171], a[40:43], v[248:251], v[168:171]
    buffer_load_dwordx4 v[228:231], v6, s[16:19], s81 offen sc1
    v_mov_b32 v105, 0
    v_mfma_f32_16x16x32_bf16 v[172:175], a[44:47], v[248:251], v[172:175]
    v_mov_b32 v106, 0
    s_waitcnt vmcnt(10)
    v_mfma_f32_16x16x32_bf16 v[160:163], a[48:51], v[252:255], v[160:163]
    v_mov_b32 v107, 0
    v_mov_b32 v108, 0
    v_mfma_f32_16x16x32_bf16 v[164:167], a[52:55], v[252:255], v[164:167]
    v_mov_b32 v109, 0
    v_mov_b32 v110, 0
    v_mfma_f32_16x16x32_bf16 v[168:171], a[56:59], v[252:255], v[168:171]
    v_mov_b32 v111, 0
    v_mov_b32 v4, 0xbfb8aa3b
    v_mfma_f32_16x16x32_bf16 v[172:175], a[60:63], v[252:255], v[172:175]
    ds_write_b128 v117, v[128:131] offset:0
    s_waitcnt vmcnt(9)
    v_mfma_f32_16x16x32_bf16 v[160:163], a[64:67], v[192:195], v[160:163]
    ds_write_b128 v118, v[132:135] offset:0
    v_mfma_f32_16x16x32_bf16 v[164:167], a[68:71], v[192:195], v[164:167]
    ds_write_b128 v117, v[136:139] offset:128
    v_mfma_f32_16x16x32_bf16 v[168:171], a[72:75], v[192:195], v[168:171]
    ds_write_b128 v118, v[140:143] offset:128
    v_mfma_f32_16x16x32_bf16 v[172:175], a[76:79], v[192:195], v[172:175]
    ds_write_b128 v117, v[144:147] offset:4096
    s_waitcnt vmcnt(8)
    v_mfma_f32_16x16x32_bf16 v[160:163], a[80:83], v[196:199], v[160:163]
    buffer_load_dwordx4 v[232:235], v7, s[16:19], s62 offen sc1
    buffer_load_dwordx4 v[236:239], v7, s[16:19], s0 offen sc1
    v_mfma_f32_16x16x32_bf16 v[164:167], a[84:87], v[196:199], v[164:167]
    ds_write_b128 v118, v[148:151] offset:4096
    v_mfma_f32_16x16x32_bf16 v[168:171], a[88:91], v[196:199], v[168:171]
    ds_write_b128 v117, v[152:155] offset:4224
    v_mfma_f32_16x16x32_bf16 v[172:175], a[92:95], v[196:199], v[172:175]
    ds_write_b128 v118, v[156:159] offset:4224
    s_waitcnt vmcnt(9)
    v_mfma_f32_16x16x32_bf16 v[160:163], a[96:99], v[200:203], v[160:163]
    ds_read_b32 v0, v61
    v_mfma_f32_16x16x32_bf16 v[164:167], a[100:103], v[200:203], v[164:167]
    buffer_load_dwordx4 v[240:243], v7, s[16:19], s1 offen sc1
    ds_read_b32 v0, v61
    v_mfma_f32_16x16x32_bf16 v[168:171], a[104:107], v[200:203], v[168:171]
    v_mfma_f32_16x16x32_bf16 v[172:175], a[108:111], v[200:203], v[172:175]
    s_waitcnt vmcnt(9)
    v_mfma_f32_16x16x32_bf16 v[160:163], a[112:115], v[204:207], v[160:163]
    v_mfma_f32_16x16x32_bf16 v[164:167], a[116:119], v[204:207], v[164:167]
    v_mfma_f32_16x16x32_bf16 v[168:171], a[120:123], v[204:207], v[168:171]
    buffer_load_dwordx4 v[244:247], v7, s[16:19], s3 offen sc1
    v_mfma_f32_16x16x32_bf16 v[172:175], a[124:127], v[204:207], v[172:175]
    s_waitcnt lgkmcnt(2)
    s_barrier
    s_waitcnt vmcnt(9)
    v_mfma_f32_16x16x32_bf16 v[160:163], a[128:131], v[208:211], v[160:163]
    ds_read_b128 v[64:67], v121 offset:0
    ds_read_b128 v[68:71], v122 offset:0
    v_mfma_f32_16x16x32_bf16 v[164:167], a[132:135], v[208:211], v[164:167]
    ds_read_b128 v[72:75], v121 offset:12288
    s_mov_b32 s83, 0
    v_mfma_f32_16x16x32_bf16 v[168:171], a[136:139], v[208:211], v[168:171]
    ds_read_b128 v[76:79], v122 offset:12288
    s_atomic_add s83, s[16:17], s59 glc
    v_mfma_f32_16x16x32_bf16 v[172:175], a[140:143], v[208:211], v[172:175]
    buffer_load_dwordx4 v[248:251], v7, s[16:19], s39 offen sc1
    s_waitcnt vmcnt(9)
    v_mfma_f32_16x16x32_bf16 v[160:163], a[144:147], v[212:215], v[160:163]
    ds_read_b128 v[80:83], v121 offset:24576
    ds_read_b128 v[84:87], v122 offset:24576
    v_mfma_f32_16x16x32_bf16 v[164:167], a[148:151], v[212:215], v[164:167]
    ds_read_b128 v[88:91], v121 offset:36864
    v_mfma_f32_16x16x32_bf16 v[168:171], a[152:155], v[212:215], v[168:171]
    ds_read_b128 v[92:95], v122 offset:36864
    v_mfma_f32_16x16x32_bf16 v[172:175], a[156:159], v[212:215], v[172:175]
    ds_read_b32 v0, v61
    s_waitcnt vmcnt(8)
    v_mfma_f32_16x16x32_bf16 v[160:163], a[160:163], v[216:219], v[160:163]
    buffer_load_dwordx4 v[252:255], v7, s[16:19], s40 offen sc1
    v_mfma_f32_16x16x32_bf16 v[164:167], a[164:167], v[216:219], v[164:167]
    v_mfma_f32_16x16x32_bf16 v[168:171], a[168:171], v[216:219], v[168:171]
    v_mfma_f32_16x16x32_bf16 v[172:175], a[172:175], v[216:219], v[172:175]
    s_waitcnt vmcnt(8)
    v_mfma_f32_16x16x32_bf16 v[160:163], a[176:179], v[220:223], v[160:163]
    v_mfma_f32_16x16x32_bf16 v[164:167], a[180:183], v[220:223], v[164:167]
    buffer_load_dwordx4 v[192:195], v7, s[16:19], s50 offen sc1
    s_waitcnt lgkmcnt(1)
    v_mfma_f32_16x16x32_bf16 v[168:171], a[184:187], v[220:223], v[168:171]
    v_add_u32 v121, 0xc000, v121
    v_add_u32 v122, 0xc000, v122
    v_mfma_f32_16x16x32_bf16 v[172:175], a[188:191], v[220:223], v[172:175]
    v_add_f32 v64, v64, v72
    s_waitcnt vmcnt(8)
    v_mfma_f32_16x16x32_bf16 v[160:163], a[192:195], v[224:227], v[160:163]
    v_add_f32 v65, v65, v73
    v_add_f32 v66, v66, v74
    v_mfma_f32_16x16x32_bf16 v[164:167], a[196:199], v[224:227], v[164:167]
    v_add_f32 v67, v67, v75
    v_mfma_f32_16x16x32_bf16 v[168:171], a[200:203], v[224:227], v[168:171]
    buffer_load_dwordx4 v[196:199], v7, s[16:19], s51 offen sc1
    v_add_f32 v68, v68, v76
    v_mfma_f32_16x16x32_bf16 v[172:175], a[204:207], v[224:227], v[172:175]
    v_add_f32 v69, v69, v77
    s_waitcnt vmcnt(8)
    v_mfma_f32_16x16x32_bf16 v[160:163], a[208:211], v[228:231], v[160:163]
    v_add_f32 v70, v70, v78
    v_add_f32 v71, v71, v79
    v_mfma_f32_16x16x32_bf16 v[164:167], a[212:215], v[228:231], v[164:167]
    v_add_f32 v64, v64, v80
    v_mfma_f32_16x16x32_bf16 v[168:171], a[216:219], v[228:231], v[168:171]
    v_add_f32 v65, v65, v81
    v_mfma_f32_16x16x32_bf16 v[172:175], a[220:223], v[228:231], v[172:175]
    buffer_load_dwordx4 v[200:203], v7, s[16:19], s52 offen sc1
    s_waitcnt vmcnt(8)
    v_mfma_f32_16x16x32_bf16 v[176:179], a[0:3], v[232:235], 0
    v_add_f32 v66, v66, v82
    v_add_f32 v67, v67, v83
    v_mfma_f32_16x16x32_bf16 v[180:183], a[4:7], v[232:235], 0
    v_add_f32 v68, v68, v84
    v_add_f32 v69, v69, v85
    v_mfma_f32_16x16x32_bf16 v[184:187], a[8:11], v[232:235], 0
    v_add_f32 v70, v70, v86
    v_mfma_f32_16x16x32_bf16 v[188:191], a[12:15], v[232:235], 0
    v_add_f32 v71, v71, v87
    s_waitcnt vmcnt(7)
    v_mfma_f32_16x16x32_bf16 v[176:179], a[16:19], v[236:239], v[176:179]
    buffer_load_dwordx4 v[204:207], v7, s[16:19], s53 offen sc1
    v_add_f32 v64, v64, v88
    v_mfma_f32_16x16x32_bf16 v[180:183], a[20:23], v[236:239], v[180:183]
    v_add_f32 v65, v65, v89
    v_add_f32 v66, v66, v90
    v_mfma_f32_16x16x32_bf16 v[184:187], a[24:27], v[236:239], v[184:187]
    v_add_f32 v67, v67, v91
    v_mfma_f32_16x16x32_bf16 v[188:191], a[28:31], v[236:239], v[188:191]
    v_add_f32 v68, v68, v92
    s_waitcnt vmcnt(7)
    v_mfma_f32_16x16x32_bf16 v[176:179], a[32:35], v[240:243], v[176:179]
    ds_write_b128 v117, v[160:163] offset:49152
    v_mfma_f32_16x16x32_bf16 v[180:183], a[36:39], v[240:243], v[180:183]
    buffer_load_dwordx4 v[208:211], v7, s[16:19], s54 offen sc1
    v_add_f32 v69, v69, v93
    v_mfma_f32_16x16x32_bf16 v[184:187], a[40:43], v[240:243], v[184:187]
    v_add_f32 v70, v70, v94
    v_add_f32 v71, v71, v95
    v_mfma_f32_16x16x32_bf16 v[188:191], a[44:47], v[240:243], v[188:191]
    v_mul_f32 v72, 0xbfb8aa3b, v64
    s_waitcnt vmcnt(7)
    v_mfma_f32_16x16x32_bf16 v[176:179], a[48:51], v[244:247], v[176:179]
    v_mul_f32 v73, 0xbfb8aa3b, v65
    v_mul_f32 v74, 0xbfb8aa3b, v66
    v_mfma_f32_16x16x32_bf16 v[180:183], a[52:55], v[244:247], v[180:183]
    v_mul_f32 v75, 0xbfb8aa3b, v67
    v_mul_f32 v76, 0xbfb8aa3b, v68
    v_mfma_f32_16x16x32_bf16 v[184:187], a[56:59], v[244:247], v[184:187]
    buffer_load_dwordx4 v[212:215], v7, s[16:19], s55 offen sc1
    v_mul_f32 v77, 0xbfb8aa3b, v69
    v_mfma_f32_16x16x32_bf16 v[188:191], a[60:63], v[244:247], v[188:191]
    v_mul_f32 v78, 0xbfb8aa3b, v70
    s_waitcnt vmcnt(7)
    v_mfma_f32_16x16x32_bf16 v[176:179], a[64:67], v[248:251], v[176:179]
    v_mul_f32 v79, 0xbfb8aa3b, v71
    v_mfma_f32_16x16x32_bf16 v[180:183], a[68:71], v[248:251], v[180:183]
    v_exp_f32 v72, v72
    v_mfma_f32_16x16x32_bf16 v[184:187], a[72:75], v[248:251], v[184:187]
    v_exp_f32 v73, v73
    v_mfma_f32_16x16x32_bf16 v[188:191], a[76:79], v[248:251], v[188:191]
    buffer_load_dwordx4 v[216:219], v7, s[16:19], s80 offen sc1
    s_waitcnt vmcnt(7)
    v_mfma_f32_16x16x32_bf16 v[176:179], a[80:83], v[252:255], v[176:179]
    ds_write_b128 v118, v[164:167] offset:49152
    v_mfma_f32_16x16x32_bf16 v[180:183], a[84:87], v[252:255], v[180:183]
    v_exp_f32 v74, v74
    v_mfma_f32_16x16x32_bf16 v[184:187], a[88:91], v[252:255], v[184:187]
    v_exp_f32 v75, v75
    v_mfma_f32_16x16x32_bf16 v[188:191], a[92:95], v[252:255], v[188:191]
    v_exp_f32 v76, v76
    s_waitcnt vmcnt(6)
    v_mfma_f32_16x16x32_bf16 v[176:179], a[96:99], v[192:195], v[176:179]
    buffer_load_dwordx4 v[220:223], v7, s[16:19], s81 offen sc1
    v_mfma_f32_16x16x32_bf16 v[180:183], a[100:103], v[192:195], v[180:183]
    v_exp_f32 v77, v77
    v_mfma_f32_16x16x32_bf16 v[184:187], a[104:107], v[192:195], v[184:187]
    v_exp_f32 v78, v78
    v_mfma_f32_16x16x32_bf16 v[188:191], a[108:111], v[192:195], v[188:191]
    v_exp_f32 v79, v79
    s_waitcnt vmcnt(6)
    v_mfma_f32_16x16x32_bf16 v[176:179], a[112:115], v[196:199], v[176:179]
    v_mul_f32 v24, v24, v64
    v_mul_f32 v25, v25, v65
    v_mfma_f32_16x16x32_bf16 v[180:183], a[116:119], v[196:199], v[180:183]
    v_mul_f32 v26, v26, v66
    v_mul_f32 v27, v27, v67
    v_mfma_f32_16x16x32_bf16 v[184:187], a[120:123], v[196:199], v[184:187]
    ds_write_b128 v117, v[168:171] offset:49280
    v_mfma_f32_16x16x32_bf16 v[188:191], a[124:127], v[196:199], v[188:191]
    v_mul_f32 v28, v28, v68
    s_waitcnt vmcnt(5)
    v_mfma_f32_16x16x32_bf16 v[176:179], a[128:131], v[200:203], v[176:179]
    v_mul_f32 v29, v29, v69
    v_mul_f32 v30, v30, v70
    v_mfma_f32_16x16x32_bf16 v[180:183], a[132:135], v[200:203], v[180:183]
    s_waitcnt lgkmcnt(0)
    s_cmp_ge_u32 s83, 16
    s_cbranch_scc0 L_slow_24
L_back_25:
    v_mfma_f32_16x16x32_bf16 v[184:187], a[136:139], v[200:203], v[184:187]
    s_mov_b32 m0, s69
    v_mul_f32 v31, v31, v71
    v_mfma_f32_16x16x32_bf16 v[188:191], a[140:143], v[200:203], v[188:191]
    s_add_u32 s4, s68, 32752
    s_waitcnt vmcnt(4)
    v_mfma_f32_16x16x32_bf16 v[176:179], a[144:147], v[204:207], v[176:179]
    buffer_load_dwordx4 v112, s[16:19], s68 offen sc1 lds
    buffer_load_dwordx4 v112, s[16:19], s4 offen offset:1040 sc1 lds
    v_mfma_f32_16x16x32_bf16 v[180:183], a[148:151], v[204:207], v[180:183]
    v_add_f32 v72, 1.0, v72
    v_add_f32 v73, 1.0, v73
    v_mfma_f32_16x16x32_bf16 v[184:187], a[152:155], v[204:207], v[184:187]
    v_add_f32 v74, 1.0, v74
    v_add_f32 v75, 1.0, v75
    v_mfma_f32_16x16x32_bf16 v[188:191], a[156:159], v[204:207], v[188:191]
    v_add_f32 v76, 1.0, v76
    s_waitcnt vmcnt(5)
    v_mfma_f32_16x16x32_bf16 v[176:179], a[160:163], v[208:211], v[176:179]
    v_add_f32 v77, 1.0, v77
    v_add_f32 v78, 1.0, v78
    v_mfma_f32_16x16x32_bf16 v[180:183], a[164:167], v[208:211], v[180:183]
    ds_write_b128 v118, v[172:175] offset:49280
    v_mfma_f32_16x16x32_bf16 v[184:187], a[168:171], v[208:211], v[184:187]
    v_add_f32 v79, 1.0, v79
    v_mfma_f32_16x16x32_bf16 v[188:191], a[172:175], v[208:211], v[188:191]
    v_rcp_f32 v72, v72
    s_waitcnt vmcnt(4)
    v_mfma_f32_16x16x32_bf16 v[176:179], a[176:179], v[212:215], v[176:179]
    v_rcp_f32 v73, v73
    v_mfma_f32_16x16x32_bf16 v[180:183], a[180:183], v[212:215], v[180:183]
    v_rcp_f32 v74, v74
    v_mfma_f32_16x16x32_bf16 v[184:187], a[184:187], v[212:215], v[184:187]
    v_rcp_f32 v75, v75
    v_mfma_f32_16x16x32_bf16 v[188:191], a[188:191], v[212:215], v[188:191]
    v_rcp_f32 v76, v76
    s_waitcnt vmcnt(3)
    v_mfma_f32_16x16x32_bf16 v[176:179], a[192:195], v[216:219], v[176:179]
    v_rcp_f32 v77, v77
    v_mfma_f32_16x16x32_bf16 v[180:183], a[196:199], v[216:219], v[180:183]
    v_rcp_f32 v78, v78
    v_mfma_f32_16x16x32_bf16 v[184:187], a[200:203], v[216:219], v[184:187]
    v_rcp_f32 v79, v79
    v_mfma_f32_16x16x32_bf16 v[188:191], a[204:207], v[216:219], v[188:191]
    v_mul_f32 v24, v24, v72
    s_waitcnt vmcnt(2)
    v_mfma_f32_16x16x32_bf16 v[176:179], a[208:211], v[220:223], v[176:179]
    v_mul_f32 v25, v25, v73
    v_mul_f32 v26, v26, v74
    v_mfma_f32_16x16x32_bf16 v[180:183], a[212:215], v[220:223], v[180:183]
    v_mul_f32 v27, v27, v75
    v_mul_f32 v28, v28, v76
    v_mfma_f32_16x16x32_bf16 v[184:187], a[216:219], v[220:223], v[184:187]
    v_mul_f32 v29, v29, v77
    v_mul_f32 v30, v30, v78
    v_mfma_f32_16x16x32_bf16 v[188:191], a[220:223], v[220:223], v[188:191]
    v_mul_f32 v31, v31, v79
    s_nop 4
    ds_write_b128 v117, v[176:179] offset:53248
    ds_write_b128 v118, v[180:183] offset:53248
    ds_write_b128 v117, v[184:187] offset:53376
    ds_write_b128 v118, v[188:191] offset:53376
    s_waitcnt vmcnt(0) lgkmcnt(0)
    s_barrier
    ds_read_u16_d16_hi v96, v115 offset:0
    ds_read_u16_d16_hi v97, v115 offset:128
    ds_read_u16_d16_hi v98, v115 offset:256
    ds_read_u16_d16_hi v99, v115 offset:384
    ds_read_u16_d16_hi v100, v115 offset:512
    ds_read_u16_d16_hi v101, v115 offset:640
    ds_read_u16_d16_hi v102, v115 offset:768
    ds_read_u16_d16_hi v103, v115 offset:896
    ds_read_b128 v[64:67], v121 offset:0
    ds_read_b128 v[68:71], v122 offset:0
    ds_read_b128 v[72:75], v121 offset:12288
    ds_read_b128 v[76:79], v122 offset:12288
    ds_read_b128 v[80:83], v121 offset:24576
    ds_read_b128 v[84:87], v122 offset:24576
    ds_read_b128 v[88:91], v121 offset:36864
    ds_read_b128 v[92:95], v122 offset:36864
    ds_read_u16_d16_hi v104, v116 offset:0
    ds_read_u16_d16_hi v105, v116 offset:128
    ds_read_u16_d16_hi v106, v116 offset:256
    ds_read_u16_d16_hi v107, v116 offset:384
    ds_read_u16_d16_hi v108, v116 offset:512
    ds_read_u16_d16_hi v109, v116 offset:640
    ds_read_u16_d16_hi v110, v116 offset:768
    ds_read_u16_d16_hi v111, v116 offset:896
    s_waitcnt lgkmcnt(14)
    v_pk_fma_f32 v[24:25], v[24:25], v[96:97], v[8:9]
    v_pk_fma_f32 v[26:27], v[26:27], v[98:99], v[10:11]
    v_pk_fma_f32 v[28:29], v[28:29], v[100:101], v[12:13]
    v_pk_fma_f32 v[30:31], v[30:31], v[102:103], v[14:15]
    v_cvt_pk_bf16_f32 v40, v24, v25
    v_cvt_pk_bf16_f32 v41, v26, v27
    v_cvt_pk_bf16_f32 v42, v28, v29
    v_cvt_pk_bf16_f32 v43, v30, v31
    buffer_store_dwordx4 v[40:43], v113, s[28:31], s70 offen sc1
    s_waitcnt lgkmcnt(8)
    v_pk_add_f32 v[64:65], v[64:65], v[72:73]
    v_pk_add_f32 v[80:81], v[80:81], v[88:89]
    v_pk_add_f32 v[66:67], v[66:67], v[74:75]
    v_pk_add_f32 v[82:83], v[82:83], v[90:91]
    v_pk_add_f32 v[68:69], v[68:69], v[76:77]
    v_pk_add_f32 v[84:85], v[84:85], v[92:93]
    v_pk_add_f32 v[70:71], v[70:71], v[78:79]
    v_pk_add_f32 v[86:87], v[86:87], v[94:95]
    v_pk_add_f32 v[64:65], v[64:65], v[80:81]
    v_pk_add_f32 v[66:67], v[66:67], v[82:83]
    v_pk_add_f32 v[68:69], v[68:69], v[84:85]
    v_pk_add_f32 v[70:71], v[70:71], v[86:87]
    v_pk_mul_f32 v[72:73], v[64:65], v[4:5] op_sel_hi:[1,0]
    v_pk_mul_f32 v[74:75], v[66:67], v[4:5] op_sel_hi:[1,0]
    v_pk_mul_f32 v[76:77], v[68:69], v[4:5] op_sel_hi:[1,0]
    v_pk_mul_f32 v[78:79], v[70:71], v[4:5] op_sel_hi:[1,0]
    v_exp_f32 v72, v72
    v_exp_f32 v73, v73
    v_exp_f32 v74, v74
    v_exp_f32 v75, v75
    v_exp_f32 v76, v76
    v_exp_f32 v77, v77
    v_exp_f32 v78, v78
    v_exp_f32 v79, v79
    s_waitcnt lgkmcnt(0)
    v_pk_mul_f32 v[104:105], v[104:105], v[32:33]
    v_pk_mul_f32 v[106:107], v[106:107], v[34:35]
    v_pk_mul_f32 v[108:109], v[108:109], v[36:37]
    v_pk_mul_f32 v[110:111], v[110:111], v[38:39]
    v_pk_mul_f32 v[64:65], v[64:65], v[104:105]
    v_pk_mul_f32 v[66:67], v[66:67], v[106:107]
    v_pk_mul_f32 v[68:69], v[68:69], v[108:109]
    v_pk_mul_f32 v[70:71], v[70:71], v[110:111]
    v_pk_add_f32 v[72:73], v[72:73], 1.0 op_sel_hi:[1,0]
    v_pk_add_f32 v[74:75], v[74:75], 1.0 op_sel_hi:[1,0]
    v_pk_add_f32 v[76:77], v[76:77], 1.0 op_sel_hi:[1,0]
    v_pk_add_f32 v[78:79], v[78:79], 1.0 op_sel_hi:[1,0]
    v_rcp_f32 v72, v72
    v_rcp_f32 v73, v73
    v_rcp_f32 v74, v74
    v_rcp_f32 v75, v75
    v_rcp_f32 v76, v76
    v_rcp_f32 v77, v77
    v_rcp_f32 v78, v78
    v_rcp_f32 v79, v79
    v_pk_fma_f32 v[64:65], v[64:65], v[72:73], v[16:17]
    v_pk_fma_f32 v[66:67], v[66:67], v[74:75], v[18:19]
    v_pk_fma_f32 v[68:69], v[68:69], v[76:77], v[20:21]
    v_pk_fma_f32 v[70:71], v[70:71], v[78:79], v[22:23]
    v_cvt_pk_bf16_f32 v44, v64, v65
    v_cvt_pk_bf16_f32 v45, v66, v67
    v_cvt_pk_bf16_f32 v46, v68, v69
    v_cvt_pk_bf16_f32 v47, v70, v71
    buffer_store_dwordx4 v[44:47], v113, s[28:31], s71 offen sc1
L_exit:
    s_endpgm
L_service:
    s_sub_u32 s85, s2, 224
    s_lshl_b32 s6, s85, 16
    s_lshr_b32 s7, s92, 1
    s_and_b32 s4, s92, 1
    v_lshlrev_b32 v8, 10, v6
    v_lshl_add_u32 v8, v7, 4, v8
    v_add_u32 v8, s6, v8
    v_subrev_u32 v12, 8192, v8
    s_mul_i32 s5, s4, 3
    s_add_u32 s5, s5, 5
    s_cmp_eq_u32 s85, 0
    s_cselect_b32 s5, 8, s5
    v_cmp_le_u32 vcc, s5, v6
    v_add_u32 v9, 7136, v8
    v_bfrev_b32 v29, 1
    v_cndmask_b32 v12, v29, v12, vcc
    v_add_u32 v10, 14272, v8
    s_mul_i32 s44, s92, 9504
    s_lshl_b32 s46, s7, 7
    s_mov_b32 s14, 2097152
    s_lshl_b32 s5, s92, 10
    v_add_u32 v13, s5, v2
    s_add_u32 m0, s5, 152064
    s_cmp_eq_u32 s4, 0
    s_waitcnt lgkmcnt(0)
    s_cselect_b32 s12, s80, s82
    s_cselect_b32 s13, s81, s83
    buffer_load_dwordx4 v[64:67], v96, s[8:11], s79 offen
    buffer_load_dwordx4 v[68:71], v96, s[8:11], s79 offen offset:512
    global_load_lds_dwordx4 v13, s[42:43]
    s_mov_b32 m0, s44
    s_add_u32 s45, s46, 24576
    buffer_load_dwordx4 v12, s[12:15], s46 offen lds
    s_add_u32 m0, s44, 1056
    s_nop 0
    buffer_load_dwordx4 v8, s[12:15], s46 offen offset:0 nt lds
    buffer_load_dwordx4 v9, s[12:15], s46 offen offset:1056 nt lds
    buffer_load_dwordx4 v10, s[12:15], s46 offen offset:2112 nt lds
    s_add_u32 m0, s44, 4224
    s_nop 0
    buffer_load_dwordx4 v8, s[12:15], s45 offen offset:0 nt lds
L_service_rest:
    s_lshl_b32 s5, s92, 3
    v_add_u32 v11, s5, v6
    v_lshlrev_b32 v14, 5, v11
    v_add_u32 v14, 152064, v14
    v_sub_u32 v13, 7, v7
    v_mul_u32_u24 v13, 1056, v13
    v_lshl_add_u32 v13, v6, 3, v13
    s_mul_i32 s5, s7, 19008
    s_lshl_b32 s4, s4, 6
    s_add_u32 s5, s5, s4
    v_add_u32 v13, s5, v13
    v_mul_u32_u24 v15, 16896, v11
    v_lshl_add_u32 v15, v7, 4, v15
    s_lshl_b32 s5, s85, 7
L_pad5:
    s_cbranch_execz L_return
    s_sub_u32 s48, 8392576, s5
    s_lshl_b32 s4, s92, 12
    s_add_u32 s4, s4, s5
    s_add_u32 s56, s4, 16515072
    s_mov_b32 s18, 16777216
    s_mov_b32 s19, 0x20000
    s_mov_b32 s22, 1835008
    s_mov_b32 s23, 0x20000
    s_mov_b32 s26, 2097152
    s_mov_b32 s27, 0x20000
    s_mov_b32 s30, 2097152
    s_mov_b32 s31, 0x20000
    s_mov_b32 s34, 256
    s_mov_b32 s35, 0x20000
    v_cmp_eq_u32 vcc, 0, v1
    s_lshl_b32 s86, s86, 2
    s_and_b32 s4, s91, 3
    v_bfrev_b32 v62, 1
    v_lshlrev_b32 v61, 3, v1
    v_cndmask_b32 v62, v62, 0, vcc
    s_add_u32 s86, s86, s4
    s_lshr_b32 s4, s91, 2
    s_xor_b32 s87, s4, 4
    s_lshr_b32 s4, s4, 2
    s_and_b32 s5, s90, 1
    s_lshl_b32 s5, s5, 1
    s_add_u32 s4, s4, s5
    s_lshl_b32 s4, s4, 2
    s_add_u32 s4, s4, s92
    s_lshl_b32 s4, s4, 10
    s_add_u32 s60, s4, 16515072
    s_lshr_b32 s4, s92, 1
    s_and_b32 s77, s92, 1
    s_lshl_b32 s5, s90, 5
    s_add_u32 s5, s5, s91
    s_lshl_b32 s5, s5, 1
    s_add_u32 s5, s5, s4
    s_lshl_b32 s6, s77, 9
    s_add_u32 s6, s6, s5
    s_lshr_b32 s6, s6, 4
    s_lshl_b32 s6, s6, 7
    s_add_u32 s57, s6, 16384000
    s_mov_b32 s82, 0
    s_add_u32 s83, s91, 4
    s_and_b32 s83, s83, 24
    s_cbranch_scc1 L_clr_26
    s_atomic_and s82, s[16:17], s56
L_clr_26:
    s_and_b32 s83, s5, 15
    s_cbranch_scc1 L_clr_27
    s_atomic_and s82, s[16:17], s57
L_clr_27:
    v_lshrrev_b32 v98, 4, v1
    s_mul_i32 s61, s92, 12288
    s_add_u32 s5, s61, 57344
    v_add_u32 v58, s5, v2
    s_xor_b32 s5, s92, 1
    s_mul_i32 s5, s5, 12288
    s_add_u32 s5, s5, 57344
    v_add_u32 v59, s5, v2
    v_lshlrev_b32 v102, 1, v98
    v_xor_b32 v102, v7, v102
    v_lshlrev_b32 v102, 4, v102
    v_lshl_add_u32 v48, v6, 10, v102
    s_mul_i32 s6, s92, 458752
    s_lshl_b32 s5, s87, 7
    s_add_u32 s6, s6, s5
    v_add_u32 v48, s6, v48
    v_add_u32 v49, 7168, v48
    v_add_u32 v50, 14336, v48
    v_add_u32 v51, 21504, v48
    s_bfe_u32 s6, s86, 0x10001
    s_mul_i32 s6, s6, 3
    s_xor_b32 s7, s87, 3
    s_min_u32 s7, s7, 1
    s_sub_u32 s7, 1, s7
    s_mul_i32 s6, s6, s7
    s_xor_b32 s93, s86, s87
    s_and_b32 s93, s93, 1
    s_mul_i32 s93, s93, 7
    s_add_u32 s6, s6, s93
    s_min_u32 s7, s90, 6
    s_add_u32 s93, s6, s7
    s_sub_u32 s7, s93, 14
    s_min_u32 s93, s93, s7
    s_lshl_b32 s93, s93, 15
    s_mov_b32 s62, s93
    s_add_u32 s6, s93, 32768
    s_sub_u32 s7, s6, 458752
    s_min_u32 s0, s6, s7
    s_add_u32 s6, s93, 65536
    s_sub_u32 s7, s6, 458752
    s_min_u32 s1, s6, s7
    s_add_u32 s6, s93, 196608
    s_sub_u32 s7, s6, 458752
    s_min_u32 s50, s6, s7
    s_add_u32 s6, s93, 229376
    s_sub_u32 s7, s6, 458752
    s_min_u32 s51, s6, s7
    s_add_u32 s6, s93, 262144
    s_sub_u32 s7, s6, 458752
    s_min_u32 s52, s6, s7
    s_mov_b64 exec, 0
    s_cmp_lg_u32 s92, 0
    s_cbranch_scc1 L_w_29
    s_call_b64 s[6:7], L_pad5
    s_branch L_visited_28
L_w_29:
    s_cmp_lg_u32 s92, 1
    s_cbranch_scc1 L_w_30
    s_call_b64 s[6:7], L_pad6
    s_branch L_visited_28
L_w_30:
    s_cmp_lg_u32 s92, 2
    s_cbranch_scc1 L_w_31
    s_call_b64 s[6:7], L_pad7
    s_branch L_visited_28
L_w_31:
    s_call_b64 s[6:7], L_return
L_visited_28:
    s_mov_b64 exec, -1
    buffer_load_dwordx4 v9, s[12:15], s45 offen offset:1056 nt lds
    s_waitcnt vmcnt(7)
    v_lshlrev_b32 v72, 16, v64
    v_and_b32 v73, 0xffff0000, v64
    v_lshlrev_b32 v74, 16, v65
    v_and_b32 v75, 0xffff0000, v65
    v_lshlrev_b32 v76, 16, v66
    v_and_b32 v77, 0xffff0000, v66
    v_lshlrev_b32 v78, 16, v67
    v_and_b32 v79, 0xffff0000, v67
    v_lshlrev_b32 v80, 16, v68
    v_and_b32 v81, 0xffff0000, v68
    v_lshlrev_b32 v82, 16, v69
    v_and_b32 v83, 0xffff0000, v69
    v_lshlrev_b32 v84, 16, v70
    v_and_b32 v85, 0xffff0000, v70
    v_lshlrev_b32 v86, 16, v71
    buffer_load_dwordx4 v10, s[12:15], s45 offen offset:2112 nt lds
    v_and_b32 v87, 0xffff0000, v71
    v_pk_add_f32 v[88:89], v[72:73], v[74:75]
    v_pk_add_f32 v[88:89], v[88:89], v[76:77]
    v_pk_add_f32 v[88:89], v[88:89], v[78:79]
    v_pk_add_f32 v[88:89], v[88:89], v[80:81]
    v_pk_add_f32 v[88:89], v[88:89], v[82:83]
    v_pk_add_f32 v[88:89], v[88:89], v[84:85]
    v_pk_add_f32 v[88:89], v[88:89], v[86:87]
    v_add_f32 v88, v88, v89
    s_nop 1
    v_add_f32_dpp v88, v88, v88 quad_perm:[1,0,3,2] row_mask:0xf bank_mask:0xf
    s_nop 1
    v_add_f32_dpp v88, v88, v88 quad_perm:[2,3,0,1] row_mask:0xf bank_mask:0xf
    s_nop 1
    v_add_f32_dpp v88, v88, v88 row_half_mirror row_mask:0xf bank_mask:0xf
    s_add_u32 m0, s44, 7392
    s_add_u32 s45, s45, 24576
    buffer_load_dwordx4 v8, s[12:15], s45 offen offset:0 nt lds
    s_nop 1
    v_add_f32_dpp v88, v88, v88 row_mirror row_mask:0xf bank_mask:0xf
    v_mov_b32 v89, v88
    s_nop 1
    v_permlane16_swap_b32 v89, v88
    s_nop 0
    v_add_f32 v88, v89, v88
    v_mul_f32 v88, 0x3b000000, v88
    v_pk_add_f32 v[72:73], v[72:73], v[88:89] op_sel_hi:[1,0] neg_lo:[0,1] neg_hi:[0,1]
    v_pk_add_f32 v[74:75], v[74:75], v[88:89] op_sel_hi:[1,0] neg_lo:[0,1] neg_hi:[0,1]
    v_pk_add_f32 v[76:77], v[76:77], v[88:89] op_sel_hi:[1,0] neg_lo:[0,1] neg_hi:[0,1]
    v_pk_add_f32 v[78:79], v[78:79], v[88:89] op_sel_hi:[1,0] neg_lo:[0,1] neg_hi:[0,1]
    v_pk_add_f32 v[80:81], v[80:81], v[88:89] op_sel_hi:[1,0] neg_lo:[0,1] neg_hi:[0,1]
    v_pk_add_f32 v[82:83], v[82:83], v[88:89] op_sel_hi:[1,0] neg_lo:[0,1] neg_hi:[0,1]
    v_pk_add_f32 v[84:85], v[84:85], v[88:89] op_sel_hi:[1,0] neg_lo:[0,1] neg_hi:[0,1]
    v_pk_add_f32 v[86:87], v[86:87], v[88:89] op_sel_hi:[1,0] neg_lo:[0,1] neg_hi:[0,1]
    buffer_load_dwordx4 v9, s[12:15], s45 offen offset:1056 nt lds
    s_add_u32 s44, s44, 38016
    s_add_u32 s46, s46, 256
    v_pk_mul_f32 v[90:91], v[72:73], v[72:73]
    v_pk_fma_f32 v[90:91], v[74:75], v[74:75], v[90:91]
    v_pk_fma_f32 v[90:91], v[76:77], v[76:77], v[90:91]
    v_pk_fma_f32 v[90:91], v[78:79], v[78:79], v[90:91]
    v_pk_fma_f32 v[90:91], v[80:81], v[80:81], v[90:91]
    v_pk_fma_f32 v[90:91], v[82:83], v[82:83], v[90:91]
    v_pk_fma_f32 v[90:91], v[84:85], v[84:85], v[90:91]
    v_pk_fma_f32 v[90:91], v[86:87], v[86:87], v[90:91]
    v_add_f32 v89, v90, v91
    s_nop 1
    v_add_f32_dpp v89, v89, v89 quad_perm:[1,0,3,2] row_mask:0xf bank_mask:0xf
    s_nop 1
    v_add_f32_dpp v89, v89, v89 quad_perm:[2,3,0,1] row_mask:0xf bank_mask:0xf
    s_nop 1
    v_add_f32_dpp v89, v89, v89 row_half_mirror row_mask:0xf bank_mask:0xf
    s_mov_b32 m0, s44
    s_add_u32 s45, s46, 24576
    buffer_load_dwordx4 v12, s[12:15], s46 offen lds
    s_nop 1
    v_add_f32_dpp v89, v89, v89 row_mirror row_mask:0xf bank_mask:0xf
    v_mov_b32 v90, v89
    s_nop 1
    v_permlane16_swap_b32 v90, v89
    s_nop 0
    v_add_f32 v89, v90, v89
    v_mul_f32 v89, 0x3b000000, v89
    v_cvt_pk_bf16_f32 v88, v88, v88
    v_and_b32 v88, 0xffff0000, v88
    v_cvt_pk_bf16_f32 v89, v89, v89
    v_and_b32 v89, 0xffff0000, v89
    v_add_f32 v89, 0x3727c5ac, v89
    v_cvt_pk_bf16_f32 v89, v89, v89
    v_and_b32 v89, 0xffff0000, v89
    v_sqrt_f32 v89, v89
    s_add_u32 m0, s44, 1056
    s_nop 0
    buffer_load_dwordx4 v8, s[12:15], s46 offen offset:0 nt lds
    s_lshr_b32 s79, s79, 13
    s_lshl_b32 s79, s79, 7
    s_add_u32 s79, s79, 15990784
    s_lshl_b32 s78, s92, 4
    v_lshl_add_u32 v90, v4, 3, s78
    v_add_u32 v90, 147456, v90
    v_and_b32 v46, 48, v2
    v_add_u32 v46, 147456, v46
    v_or_b32 v47, s92, v6
    v_min_u32 v47, 1, v47
    v_lshlrev_b32 v47, 31, v47
    v_or_b32 v47, v47, v2
    v_cvt_pk_bf16_f32 v89, v89, v89
    v_and_b32 v89, 0xffff0000, v89
    ds_write_b64 v90, v[88:89]
    buffer_load_dwordx4 v9, s[12:15], s46 offen offset:1056 nt lds
    buffer_load_dwordx4 v10, s[12:15], s46 offen offset:2112 nt lds
    s_add_u32 m0, s44, 4224
    s_nop 0
    buffer_load_dwordx4 v8, s[12:15], s45 offen offset:0 nt lds
    buffer_load_dwordx4 v9, s[12:15], s45 offen offset:1056 nt lds
    buffer_load_dwordx4 v10, s[12:15], s45 offen offset:2112 nt lds
    s_add_u32 m0, s44, 7392
    s_add_u32 s45, s45, 24576
    buffer_load_dwordx4 v8, s[12:15], s45 offen offset:0 nt lds
    buffer_load_dwordx4 v9, s[12:15], s45 offen offset:1056 nt lds
    s_add_u32 s44, s44, 38016
    s_add_u32 s46, s46, 256
    s_waitcnt vmcnt(9) lgkmcnt(0)
    s_barrier
    ds_read_b128 v[40:43], v46
    ds_read_b128 v[16:19], v14 offset:0
    ds_read_b128 v[20:23], v14 offset:16
    ds_read_b64 v[64:65], v13 offset:640
    ds_read_b64 v[66:67], v13 offset:768
    ds_read_b64 v[68:69], v13 offset:896
    ds_read_b64 v[70:71], v13 offset:1056
    ds_read_b64 v[72:73], v13 offset:1184
    ds_read_b64 v[74:75], v13 offset:1312
    ds_read_b64 v[76:77], v13 offset:1440
    ds_read_b64 v[78:79], v13 offset:1568
    ds_read_b64 v[80:81], v13 offset:1696
    ds_read_b64 v[82:83], v13 offset:1824
    ds_read_b64 v[84:85], v13 offset:1952
    ds_read_b64 v[86:87], v13 offset:10560
    ds_read_b64 v[88:89], v13 offset:10688
    ds_read_b64 v[90:91], v13 offset:10816
    ds_read_b64 v[92:93], v13 offset:10944
    ds_read_b64 v[94:95], v13 offset:11072
    ds_read_b64 v[96:97], v13 offset:11200
    ds_read_b64 v[98:99], v13 offset:11328
    ds_read_b64 v[100:101], v13 offset:11456
    v_add_u32 v13, 38016, v13
    v_add_u32 v14, 1024, v14
    s_mov_b32 s83, 0xffff0000
    s_mov_b32 s80, 0x05040100
    s_mov_b32 s81, 0x07060302
    s_waitcnt lgkmcnt(14)
    buffer_store_dwordx4 v[40:43], v47, s[16:19], s79 offen sc1
    s_waitcnt lgkmcnt(0)
    v_perm_b32 v128, v64, v66, s80
    v_perm_b32 v129, v64, v66, s81
    v_perm_b32 v130, v66, v68, s80
    v_perm_b32 v131, v66, v68, s81
    v_perm_b32 v132, v68, v70, s80
    v_perm_b32 v133, v68, v70, s81
    v_perm_b32 v134, v70, v72, s80
    v_perm_b32 v135, v70, v72, s81
    v_perm_b32 v136, v72, v74, s80
    v_perm_b32 v137, v72, v74, s81
    v_perm_b32 v138, v74, v76, s80
    v_perm_b32 v139, v74, v76, s81
    v_perm_b32 v140, v76, v78, s80
    v_perm_b32 v141, v76, v78, s81
    s_mov_b32 m0, s44
    s_add_u32 s45, s46, 24576
    buffer_load_dwordx4 v12, s[12:15], s46 offen lds
    v_perm_b32 v142, v78, v80, s80
    v_perm_b32 v143, v78, v80, s81
    v_perm_b32 v144, v80, v82, s80
    v_perm_b32 v145, v80, v82, s81
    v_perm_b32 v146, v82, v84, s80
    v_perm_b32 v147, v82, v84, s81
    v_lshlrev_b32 v150, 16, v86
    v_and_b32 v151, s83, v86
    v_lshlrev_b32 v152, 16, v88
    v_and_b32 v153, s83, v88
    v_lshlrev_b32 v154, 16, v90
    v_and_b32 v155, s83, v90
    v_lshlrev_b32 v156, 16, v92
    v_and_b32 v157, s83, v92
    s_add_u32 m0, s44, 1056
    s_nop 0
    buffer_load_dwordx4 v8, s[12:15], s46 offen offset:0 nt lds
    v_lshlrev_b32 v158, 16, v94
    v_and_b32 v159, s83, v94
    v_lshlrev_b32 v160, 16, v96
    v_and_b32 v161, s83, v96
    v_lshlrev_b32 v162, 16, v98
    v_and_b32 v163, s83, v98
    v_lshlrev_b32 v164, 16, v100
    v_and_b32 v165, s83, v100
    v_dot2_f32_bf16 v172, v128, v17, 0
    v_dot2_f32_bf16 v173, v129, v19, 0
    v_dot2_f32_bf16 v174, v130, v17, 0
    v_dot2_f32_bf16 v175, v131, v19, 0
    v_dot2_f32_bf16 v176, v132, v17, 0
    v_dot2_f32_bf16 v177, v133, v19, 0
    buffer_load_dwordx4 v9, s[12:15], s46 offen offset:1056 nt lds
    v_dot2_f32_bf16 v178, v134, v17, 0
    v_dot2_f32_bf16 v179, v135, v19, 0
    v_dot2_f32_bf16 v180, v136, v17, 0
    v_dot2_f32_bf16 v181, v137, v19, 0
    v_dot2_f32_bf16 v182, v138, v17, 0
    v_dot2_f32_bf16 v183, v139, v19, 0
    v_dot2_f32_bf16 v184, v140, v17, 0
    v_dot2_f32_bf16 v185, v141, v19, 0
    v_dot2_f32_bf16 v186, v142, v17, 0
    v_dot2_f32_bf16 v187, v143, v19, 0
    v_dot2_f32_bf16 v172, v132, v16, v172
    v_dot2_f32_bf16 v173, v133, v18, v173
    v_dot2_f32_bf16 v174, v134, v16, v174
    v_dot2_f32_bf16 v175, v135, v18, v175
    buffer_load_dwordx4 v10, s[12:15], s46 offen offset:2112 nt lds
    v_dot2_f32_bf16 v176, v136, v16, v176
    v_dot2_f32_bf16 v177, v137, v18, v177
    v_dot2_f32_bf16 v178, v138, v16, v178
    v_dot2_f32_bf16 v179, v139, v18, v179
    v_dot2_f32_bf16 v180, v140, v16, v180
    v_dot2_f32_bf16 v181, v141, v18, v181
    v_dot2_f32_bf16 v182, v142, v16, v182
    v_dot2_f32_bf16 v183, v143, v18, v183
    v_dot2_f32_bf16 v184, v144, v16, v184
    v_dot2_f32_bf16 v185, v145, v18, v185
    v_dot2_f32_bf16 v186, v146, v16, v186
    v_dot2_f32_bf16 v187, v147, v18, v187
    v_pk_mul_f32 v[172:173], v[172:173], v[150:151]
    v_pk_mul_f32 v[174:175], v[174:175], v[152:153]
    s_add_u32 m0, s44, 4224
    s_nop 0
    buffer_load_dwordx4 v8, s[12:15], s45 offen offset:0 nt lds
    v_pk_mul_f32 v[176:177], v[176:177], v[154:155]
    v_pk_mul_f32 v[178:179], v[178:179], v[156:157]
    v_pk_mul_f32 v[180:181], v[180:181], v[158:159]
    v_pk_mul_f32 v[182:183], v[182:183], v[160:161]
    v_pk_mul_f32 v[184:185], v[184:185], v[162:163]
    v_pk_mul_f32 v[186:187], v[186:187], v[164:165]
    v_cvt_pk_bf16_f32 v192, v186, v184
    v_cvt_pk_bf16_f32 v193, v182, v180
    v_cvt_pk_bf16_f32 v194, v178, v176
    v_cvt_pk_bf16_f32 v195, v174, v172
    v_cvt_pk_bf16_f32 v196, v187, v185
    v_cvt_pk_bf16_f32 v197, v183, v181
    v_cvt_pk_bf16_f32 v198, v179, v177
    v_cvt_pk_bf16_f32 v199, v175, v173
    v_perm_b32 v128, v65, v67, s80
    v_perm_b32 v129, v65, v67, s81
    v_perm_b32 v130, v67, v69, s80
    v_perm_b32 v131, v67, v69, s81
    v_perm_b32 v132, v69, v71, s80
    v_perm_b32 v133, v69, v71, s81
    v_perm_b32 v134, v71, v73, s80
    v_perm_b32 v135, v71, v73, s81
    v_perm_b32 v136, v73, v75, s80
    v_perm_b32 v137, v73, v75, s81
    buffer_store_dwordx4 v[192:195], v15, s[16:19], s48 offen sc1
    s_add_u32 s48, s48, 4224
    v_perm_b32 v138, v75, v77, s80
    v_perm_b32 v139, v75, v77, s81
    v_perm_b32 v140, v77, v79, s80
    v_perm_b32 v141, v77, v79, s81
    v_perm_b32 v142, v79, v81, s80
    v_perm_b32 v143, v79, v81, s81
    v_perm_b32 v144, v81, v83, s80
    v_perm_b32 v145, v81, v83, s81
    v_perm_b32 v146, v83, v85, s80
    buffer_store_dwordx4 v[196:199], v15, s[16:19], s48 offen sc1
    s_add_u32 s48, s48, 4224
    v_perm_b32 v147, v83, v85, s81
    v_lshlrev_b32 v150, 16, v87
    v_and_b32 v151, s83, v87
    v_lshlrev_b32 v152, 16, v89
    v_and_b32 v153, s83, v89
    v_lshlrev_b32 v154, 16, v91
    v_and_b32 v155, s83, v91
    v_lshlrev_b32 v156, 16, v93
    v_and_b32 v157, s83, v93
    v_lshlrev_b32 v158, 16, v95
    buffer_load_dwordx4 v9, s[12:15], s45 offen offset:1056 nt lds
    v_and_b32 v159, s83, v95
    v_lshlrev_b32 v160, 16, v97
    v_and_b32 v161, s83, v97
    v_lshlrev_b32 v162, 16, v99
    v_and_b32 v163, s83, v99
    v_lshlrev_b32 v164, 16, v101
    v_and_b32 v165, s83, v101
    v_pk_mov_b32 v[32:33], v[20:21], v[20:21] op_sel:[0,1]
    v_pk_mov_b32 v[34:35], v[22:23], v[22:23] op_sel:[0,1]
    s_waitcnt vmcnt(9)
    s_barrier
    ds_read_b128 v[16:19], v14 offset:0
    ds_read_b128 v[20:23], v14 offset:16
    ds_read_b64 v[64:65], v13 offset:640
    ds_read_b64 v[66:67], v13 offset:768
    ds_read_b64 v[68:69], v13 offset:896
    ds_read_b64 v[70:71], v13 offset:1056
    ds_read_b64 v[72:73], v13 offset:1184
    ds_read_b64 v[74:75], v13 offset:1312
    ds_read_b64 v[76:77], v13 offset:1440
    ds_read_b64 v[78:79], v13 offset:1568
    ds_read_b64 v[80:81], v13 offset:1696
    ds_read_b64 v[82:83], v13 offset:1824
    ds_read_b64 v[84:85], v13 offset:1952
    ds_read_b64 v[86:87], v13 offset:10560
    ds_read_b64 v[88:89], v13 offset:10688
    ds_read_b64 v[90:91], v13 offset:10816
    ds_read_b64 v[92:93], v13 offset:10944
    ds_read_b64 v[94:95], v13 offset:11072
    ds_read_b64 v[96:97], v13 offset:11200
    ds_read_b64 v[98:99], v13 offset:11328
    ds_read_b64 v[100:101], v13 offset:11456
    v_add_u32 v13, 38016, v13
    v_add_u32 v14, 1024, v14
    v_dot2_f32_bf16 v172, v128, v33, 0
    v_dot2_f32_bf16 v173, v129, v35, 0
    v_dot2_f32_bf16 v174, v130, v33, 0
    v_dot2_f32_bf16 v175, v131, v35, 0
    v_dot2_f32_bf16 v176, v132, v33, 0
    v_dot2_f32_bf16 v177, v133, v35, 0
    v_dot2_f32_bf16 v178, v134, v33, 0
    v_dot2_f32_bf16 v179, v135, v35, 0
    v_dot2_f32_bf16 v180, v136, v33, 0
    v_dot2_f32_bf16 v181, v137, v35, 0
    v_dot2_f32_bf16 v182, v138, v33, 0
    v_dot2_f32_bf16 v183, v139, v35, 0
    buffer_load_dwordx4 v10, s[12:15], s45 offen offset:2112 nt lds
    v_dot2_f32_bf16 v184, v140, v33, 0
    v_dot2_f32_bf16 v185, v141, v35, 0
    v_dot2_f32_bf16 v186, v142, v33, 0
    v_dot2_f32_bf16 v187, v143, v35, 0
    v_dot2_f32_bf16 v172, v132, v32, v172
    v_dot2_f32_bf16 v173, v133, v34, v173
    v_dot2_f32_bf16 v174, v134, v32, v174
    v_dot2_f32_bf16 v175, v135, v34, v175
    v_dot2_f32_bf16 v176, v136, v32, v176
    v_dot2_f32_bf16 v177, v137, v34, v177
    v_dot2_f32_bf16 v178, v138, v32, v178
    v_dot2_f32_bf16 v179, v139, v34, v179
    s_add_u32 m0, s44, 7392
    s_add_u32 s45, s45, 24576
    buffer_load_dwordx4 v8, s[12:15], s45 offen offset:0 nt lds
    v_dot2_f32_bf16 v180, v140, v32, v180
    v_dot2_f32_bf16 v181, v141, v34, v181
    v_dot2_f32_bf16 v182, v142, v32, v182
    v_dot2_f32_bf16 v183, v143, v34, v183
    v_dot2_f32_bf16 v184, v144, v32, v184
    v_dot2_f32_bf16 v185, v145, v34, v185
    v_dot2_f32_bf16 v186, v146, v32, v186
    v_dot2_f32_bf16 v187, v147, v34, v187
    v_pk_mul_f32 v[172:173], v[172:173], v[150:151]
    v_pk_mul_f32 v[174:175], v[174:175], v[152:153]
    v_pk_mul_f32 v[176:177], v[176:177], v[154:155]
    v_pk_mul_f32 v[178:179], v[178:179], v[156:157]
    buffer_load_dwordx4 v9, s[12:15], s45 offen offset:1056 nt lds
    s_add_u32 s44, s44, 38016
    s_add_u32 s46, s46, 256
    v_pk_mul_f32 v[180:181], v[180:181], v[158:159]
    v_pk_mul_f32 v[182:183], v[182:183], v[160:161]
    v_pk_mul_f32 v[184:185], v[184:185], v[162:163]
    v_pk_mul_f32 v[186:187], v[186:187], v[164:165]
    v_cvt_pk_bf16_f32 v200, v186, v184
    v_cvt_pk_bf16_f32 v201, v182, v180
    v_cvt_pk_bf16_f32 v202, v178, v176
    v_cvt_pk_bf16_f32 v203, v174, v172
    v_cvt_pk_bf16_f32 v204, v187, v185
    v_cvt_pk_bf16_f32 v205, v183, v181
    v_cvt_pk_bf16_f32 v206, v179, v177
    v_cvt_pk_bf16_f32 v207, v175, v173
    s_waitcnt lgkmcnt(0)
    v_perm_b32 v128, v64, v66, s80
    v_perm_b32 v129, v64, v66, s81
    v_perm_b32 v130, v66, v68, s80
    v_perm_b32 v131, v66, v68, s81
    v_perm_b32 v132, v68, v70, s80
    v_perm_b32 v133, v68, v70, s81
    v_perm_b32 v134, v70, v72, s80
    v_perm_b32 v135, v70, v72, s81
    v_perm_b32 v136, v72, v74, s80
    v_perm_b32 v137, v72, v74, s81
    v_perm_b32 v138, v74, v76, s80
    buffer_store_dwordx4 v[200:203], v15, s[16:19], s48 offen sc1
    s_add_u32 s48, s48, 4224
    v_perm_b32 v139, v74, v76, s81
    v_perm_b32 v140, v76, v78, s80
    v_perm_b32 v141, v76, v78, s81
    v_perm_b32 v142, v78, v80, s80
    v_perm_b32 v143, v78, v80, s81
    v_perm_b32 v144, v80, v82, s80
    v_perm_b32 v145, v80, v82, s81
    v_perm_b32 v146, v82, v84, s80
    v_perm_b32 v147, v82, v84, s81
    v_lshlrev_b32 v150, 16, v86
    buffer_store_dwordx4 v[204:207], v15, s[16:19], s48 offen sc1
    s_add_u32 s48, s48, 528000
    v_and_b32 v151, s83, v86
    v_lshlrev_b32 v152, 16, v88
    v_and_b32 v153, s83, v88
    v_lshlrev_b32 v154, 16, v90
    v_and_b32 v155, s83, v90
    v_lshlrev_b32 v156, 16, v92
    v_and_b32 v157, s83, v92
    v_lshlrev_b32 v158, 16, v94
    v_and_b32 v159, s83, v94
    v_lshlrev_b32 v160, 16, v96
    v_and_b32 v161, s83, v96
    s_mov_b32 m0, s44
    s_add_u32 s45, s46, 24576
    buffer_load_dwordx4 v12, s[12:15], s46 offen lds
    v_lshlrev_b32 v162, 16, v98
    v_and_b32 v163, s83, v98
    v_lshlrev_b32 v164, 16, v100
    v_and_b32 v165, s83, v100
    v_dot2_f32_bf16 v172, v128, v17, 0
    v_dot2_f32_bf16 v173, v129, v19, 0
    v_dot2_f32_bf16 v174, v130, v17, 0
    v_dot2_f32_bf16 v175, v131, v19, 0
    v_dot2_f32_bf16 v176, v132, v17, 0
    v_dot2_f32_bf16 v177, v133, v19, 0
    s_add_u32 m0, s44, 1056
    s_nop 0
    buffer_load_dwordx4 v8, s[12:15], s46 offen offset:0 nt lds
    v_dot2_f32_bf16 v178, v134, v17, 0
    v_dot2_f32_bf16 v179, v135, v19, 0
    v_dot2_f32_bf16 v180, v136, v17, 0
    v_dot2_f32_bf16 v181, v137, v19, 0
    v_dot2_f32_bf16 v182, v138, v17, 0
    v_dot2_f32_bf16 v183, v139, v19, 0
    v_dot2_f32_bf16 v184, v140, v17, 0
    v_dot2_f32_bf16 v185, v141, v19, 0
    v_dot2_f32_bf16 v186, v142, v17, 0
    v_dot2_f32_bf16 v187, v143, v19, 0
    v_dot2_f32_bf16 v172, v132, v16, v172
    buffer_load_dwordx4 v9, s[12:15], s46 offen offset:1056 nt lds
    v_dot2_f32_bf16 v173, v133, v18, v173
    v_dot2_f32_bf16 v174, v134, v16, v174
    v_dot2_f32_bf16 v175, v135, v18, v175
    v_dot2_f32_bf16 v176, v136, v16, v176
    v_dot2_f32_bf16 v177, v137, v18, v177
    v_dot2_f32_bf16 v178, v138, v16, v178
    v_dot2_f32_bf16 v179, v139, v18, v179
    v_dot2_f32_bf16 v180, v140, v16, v180
    v_dot2_f32_bf16 v181, v141, v18, v181
    v_dot2_f32_bf16 v182, v142, v16, v182
    buffer_load_dwordx4 v10, s[12:15], s46 offen offset:2112 nt lds
    v_dot2_f32_bf16 v183, v143, v18, v183
    v_dot2_f32_bf16 v184, v144, v16, v184
    v_dot2_f32_bf16 v185, v145, v18, v185
    v_dot2_f32_bf16 v186, v146, v16, v186
    v_dot2_f32_bf16 v187, v147, v18, v187
    v_pk_mul_f32 v[172:173], v[172:173], v[150:151]
    v_pk_mul_f32 v[174:175], v[174:175], v[152:153]
    v_pk_mul_f32 v[176:177], v[176:177], v[154:155]
    v_pk_mul_f32 v[178:179], v[178:179], v[156:157]
    v_pk_mul_f32 v[180:181], v[180:181], v[158:159]
    v_pk_mul_f32 v[182:183], v[182:183], v[160:161]
    s_add_u32 m0, s44, 4224
    s_nop 0
    buffer_load_dwordx4 v8, s[12:15], s45 offen offset:0 nt lds
    v_pk_mul_f32 v[184:185], v[184:185], v[162:163]
    v_pk_mul_f32 v[186:187], v[186:187], v[164:165]
    v_cvt_pk_bf16_f32 v192, v186, v184
    v_cvt_pk_bf16_f32 v193, v182, v180
    v_cvt_pk_bf16_f32 v194, v178, v176
    v_cvt_pk_bf16_f32 v195, v174, v172
    v_cvt_pk_bf16_f32 v196, v187, v185
    v_cvt_pk_bf16_f32 v197, v183, v181
    v_cvt_pk_bf16_f32 v198, v179, v177
    v_cvt_pk_bf16_f32 v199, v175, v173
    v_perm_b32 v128, v65, v67, s80
    v_perm_b32 v129, v65, v67, s81
    v_perm_b32 v130, v67, v69, s80
    v_perm_b32 v131, v67, v69, s81
    v_perm_b32 v132, v69, v71, s80
    v_perm_b32 v133, v69, v71, s81
    v_perm_b32 v134, v71, v73, s80
    v_perm_b32 v135, v71, v73, s81
    v_perm_b32 v136, v73, v75, s80
    v_perm_b32 v137, v73, v75, s81
    buffer_store_dwordx4 v[192:195], v15, s[16:19], s48 offen sc1
    s_add_u32 s48, s48, 4224
    v_perm_b32 v138, v75, v77, s80
    v_perm_b32 v139, v75, v77, s81
    v_perm_b32 v140, v77, v79, s80
    v_perm_b32 v141, v77, v79, s81
    v_perm_b32 v142, v79, v81, s80
L_pad6:
    s_cbranch_execz L_return
    v_perm_b32 v143, v79, v81, s81
    v_perm_b32 v144, v81, v83, s80
    v_perm_b32 v145, v81, v83, s81
    v_perm_b32 v146, v83, v85, s80
    buffer_store_dwordx4 v[196:199], v15, s[16:19], s48 offen sc1
    s_add_u32 s48, s48, 4224
    v_perm_b32 v147, v83, v85, s81
    v_lshlrev_b32 v150, 16, v87
    v_and_b32 v151, s83, v87
    v_lshlrev_b32 v152, 16, v89
    v_and_b32 v153, s83, v89
    v_lshlrev_b32 v154, 16, v91
    v_and_b32 v155, s83, v91
    v_lshlrev_b32 v156, 16, v93
    v_and_b32 v157, s83, v93
    v_lshlrev_b32 v158, 16, v95
    buffer_load_dwordx4 v9, s[12:15], s45 offen offset:1056 nt lds
    v_and_b32 v159, s83, v95
    v_lshlrev_b32 v160, 16, v97
    v_and_b32 v161, s83, v97
    v_lshlrev_b32 v162, 16, v99
    v_and_b32 v163, s83, v99
    v_lshlrev_b32 v164, 16, v101
    v_and_b32 v165, s83, v101
    v_pk_mov_b32 v[32:33], v[20:21], v[20:21] op_sel:[0,1]
    v_pk_mov_b32 v[34:35], v[22:23], v[22:23] op_sel:[0,1]
    s_waitcnt vmcnt(10)
    s_barrier
    ds_read_b128 v[16:19], v14 offset:0
    ds_read_b128 v[20:23], v14 offset:16
    ds_read_b64 v[64:65], v13 offset:640
    ds_read_b64 v[66:67], v13 offset:768
    ds_read_b64 v[68:69], v13 offset:896
    ds_read_b64 v[70:71], v13 offset:1056
    ds_read_b64 v[72:73], v13 offset:1184
    ds_read_b64 v[74:75], v13 offset:1312
    ds_read_b64 v[76:77], v13 offset:1440
    ds_read_b64 v[78:79], v13 offset:1568
    ds_read_b64 v[80:81], v13 offset:1696
    ds_read_b64 v[82:83], v13 offset:1824
    ds_read_b64 v[84:85], v13 offset:1952
    ds_read_b64 v[86:87], v13 offset:10560
    ds_read_b64 v[88:89], v13 offset:10688
    ds_read_b64 v[90:91], v13 offset:10816
    ds_read_b64 v[92:93], v13 offset:10944
    ds_read_b64 v[94:95], v13 offset:11072
    ds_read_b64 v[96:97], v13 offset:11200
    ds_read_b64 v[98:99], v13 offset:11328
    ds_read_b64 v[100:101], v13 offset:11456
    v_add_u32 v13, 38016, v13
    v_add_u32 v14, 1024, v14
    s_and_b32 s4, s2, 1
    s_lshl_b32 s4, s4, 7
    s_cmp_eq_u32 s92, 0
    s_cselect_b32 s4, s4, 0x1000
    v_mov_b32 v4, 1
    v_add_u32 v5, s4, v62
    buffer_atomic_add v4, v5, s[32:35], 0 offen sc1
    v_dot2_f32_bf16 v172, v128, v33, 0
    v_dot2_f32_bf16 v173, v129, v35, 0
    v_dot2_f32_bf16 v174, v130, v33, 0
    v_dot2_f32_bf16 v175, v131, v35, 0
    v_dot2_f32_bf16 v176, v132, v33, 0
    v_dot2_f32_bf16 v177, v133, v35, 0
    v_dot2_f32_bf16 v178, v134, v33, 0
    v_dot2_f32_bf16 v179, v135, v35, 0
    v_dot2_f32_bf16 v180, v136, v33, 0
    v_dot2_f32_bf16 v181, v137, v35, 0
    v_dot2_f32_bf16 v182, v138, v33, 0
    v_dot2_f32_bf16 v183, v139, v35, 0
    buffer_load_dwordx4 v10, s[12:15], s45 offen offset:2112 nt lds
    v_dot2_f32_bf16 v184, v140, v33, 0
    v_dot2_f32_bf16 v185, v141, v35, 0
    v_dot2_f32_bf16 v186, v142, v33, 0
    v_dot2_f32_bf16 v187, v143, v35, 0
    v_dot2_f32_bf16 v172, v132, v32, v172
    v_dot2_f32_bf16 v173, v133, v34, v173
    v_dot2_f32_bf16 v174, v134, v32, v174
    v_dot2_f32_bf16 v175, v135, v34, v175
    v_dot2_f32_bf16 v176, v136, v32, v176
    v_dot2_f32_bf16 v177, v137, v34, v177
    v_dot2_f32_bf16 v178, v138, v32, v178
    v_dot2_f32_bf16 v179, v139, v34, v179
    s_add_u32 m0, s44, 7392
    s_add_u32 s45, s45, 24576
    buffer_load_dwordx4 v8, s[12:15], s45 offen offset:0 nt lds
    v_dot2_f32_bf16 v180, v140, v32, v180
    v_dot2_f32_bf16 v181, v141, v34, v181
    v_dot2_f32_bf16 v182, v142, v32, v182
    v_dot2_f32_bf16 v183, v143, v34, v183
    v_dot2_f32_bf16 v184, v144, v32, v184
    v_dot2_f32_bf16 v185, v145, v34, v185
    v_dot2_f32_bf16 v186, v146, v32, v186
    v_dot2_f32_bf16 v187, v147, v34, v187
    v_pk_mul_f32 v[172:173], v[172:173], v[150:151]
    v_pk_mul_f32 v[174:175], v[174:175], v[152:153]
    v_pk_mul_f32 v[176:177], v[176:177], v[154:155]
    v_pk_mul_f32 v[178:179], v[178:179], v[156:157]
    buffer_load_dwordx4 v9, s[12:15], s45 offen offset:1056 nt lds
    s_add_u32 s44, s44, 38016
    s_add_u32 s46, s46, 256
    v_pk_mul_f32 v[180:181], v[180:181], v[158:159]
    v_pk_mul_f32 v[182:183], v[182:183], v[160:161]
    v_pk_mul_f32 v[184:185], v[184:185], v[162:163]
    v_pk_mul_f32 v[186:187], v[186:187], v[164:165]
    v_cvt_pk_bf16_f32 v200, v186, v184
    v_cvt_pk_bf16_f32 v201, v182, v180
    v_cvt_pk_bf16_f32 v202, v178, v176
    v_cvt_pk_bf16_f32 v203, v174, v172
    v_cvt_pk_bf16_f32 v204, v187, v185
    v_cvt_pk_bf16_f32 v205, v183, v181
    v_cvt_pk_bf16_f32 v206, v179, v177
    v_cvt_pk_bf16_f32 v207, v175, v173
    s_waitcnt lgkmcnt(0)
    v_perm_b32 v128, v64, v66, s80
    v_perm_b32 v129, v64, v66, s81
    v_perm_b32 v130, v66, v68, s80
    v_perm_b32 v131, v66, v68, s81
    v_perm_b32 v132, v68, v70, s80
    v_perm_b32 v133, v68, v70, s81
    v_perm_b32 v134, v70, v72, s80
    v_perm_b32 v135, v70, v72, s81
    v_perm_b32 v136, v72, v74, s80
    v_perm_b32 v137, v72, v74, s81
    v_perm_b32 v138, v74, v76, s80
    buffer_store_dwordx4 v[200:203], v15, s[16:19], s48 offen sc1
    s_add_u32 s48, s48, 4224
    v_perm_b32 v139, v74, v76, s81
    v_perm_b32 v140, v76, v78, s80
    v_perm_b32 v141, v76, v78, s81
    v_perm_b32 v142, v78, v80, s80
    v_perm_b32 v143, v78, v80, s81
    v_perm_b32 v144, v80, v82, s80
    v_perm_b32 v145, v80, v82, s81
    v_perm_b32 v146, v82, v84, s80
    v_perm_b32 v147, v82, v84, s81
    v_lshlrev_b32 v150, 16, v86
    buffer_store_dwordx4 v[204:207], v15, s[16:19], s48 offen sc1
    s_add_u32 s48, s48, 528000
    v_and_b32 v151, s83, v86
    v_lshlrev_b32 v152, 16, v88
    v_and_b32 v153, s83, v88
    v_lshlrev_b32 v154, 16, v90
    v_and_b32 v155, s83, v90
    v_lshlrev_b32 v156, 16, v92
    v_and_b32 v157, s83, v92
    v_lshlrev_b32 v158, 16, v94
    v_and_b32 v159, s83, v94
    v_lshlrev_b32 v160, 16, v96
    v_and_b32 v161, s83, v96
    s_lshl_b32 s4, s90, 5
    s_add_u32 s4, s4, s91
    s_lshl_b32 s4, s4, 2
    s_add_u32 s4, s4, s92
    s_lshl_b32 s4, s4, 11
    v_lshrrev_b32 v27, 2, v1
    v_lshlrev_b32 v27, 7, v27
    buffer_load_dword v27, v27, s[24:27], s4 offen
    s_add_u32 m0, s61, 0
    s_nop 0
    buffer_load_dwordx4 v48, s[20:23], s62 offen offset:0 lds
    v_lshlrev_b32 v162, 16, v98
    v_and_b32 v163, s83, v98
    v_lshlrev_b32 v164, 16, v100
    v_and_b32 v165, s83, v100
    v_dot2_f32_bf16 v172, v128, v17, 0
    v_dot2_f32_bf16 v173, v129, v19, 0
    v_dot2_f32_bf16 v174, v130, v17, 0
    v_dot2_f32_bf16 v175, v131, v19, 0
    v_dot2_f32_bf16 v176, v132, v17, 0
    v_dot2_f32_bf16 v177, v133, v19, 0
    buffer_load_dwordx4 v49, s[20:23], s62 offen offset:1024 lds
    v_dot2_f32_bf16 v178, v134, v17, 0
    v_dot2_f32_bf16 v179, v135, v19, 0
    v_dot2_f32_bf16 v180, v136, v17, 0
    v_dot2_f32_bf16 v181, v137, v19, 0
    v_dot2_f32_bf16 v182, v138, v17, 0
    v_dot2_f32_bf16 v183, v139, v19, 0
    v_dot2_f32_bf16 v184, v140, v17, 0
    v_dot2_f32_bf16 v185, v141, v19, 0
    v_dot2_f32_bf16 v186, v142, v17, 0
    v_dot2_f32_bf16 v187, v143, v19, 0
    v_dot2_f32_bf16 v172, v132, v16, v172
    buffer_load_dwordx4 v50, s[20:23], s62 offen offset:2048 lds
    v_dot2_f32_bf16 v173, v133, v18, v173
    v_dot2_f32_bf16 v174, v134, v16, v174
    v_dot2_f32_bf16 v175, v135, v18, v175
    v_dot2_f32_bf16 v176, v136, v16, v176
    v_dot2_f32_bf16 v177, v137, v18, v177
    v_dot2_f32_bf16 v178, v138, v16, v178
    v_dot2_f32_bf16 v179, v139, v18, v179
    v_dot2_f32_bf16 v180, v140, v16, v180
    v_dot2_f32_bf16 v181, v141, v18, v181
    v_dot2_f32_bf16 v182, v142, v16, v182
    buffer_load_dwordx4 v51, s[20:23], s62 offen offset:3072 lds
    v_dot2_f32_bf16 v183, v143, v18, v183
    v_dot2_f32_bf16 v184, v144, v16, v184
    v_dot2_f32_bf16 v185, v145, v18, v185
    v_dot2_f32_bf16 v186, v146, v16, v186
    v_dot2_f32_bf16 v187, v147, v18, v187
    v_pk_mul_f32 v[172:173], v[172:173], v[150:151]
    v_pk_mul_f32 v[174:175], v[174:175], v[152:153]
    v_pk_mul_f32 v[176:177], v[176:177], v[154:155]
    v_pk_mul_f32 v[178:179], v[178:179], v[156:157]
    v_pk_mul_f32 v[180:181], v[180:181], v[158:159]
    v_pk_mul_f32 v[182:183], v[182:183], v[160:161]
    s_add_u32 m0, s61, 4096
    s_nop 0
    buffer_load_dwordx4 v48, s[20:23], s0 offen offset:0 lds
    v_pk_mul_f32 v[184:185], v[184:185], v[162:163]
    v_pk_mul_f32 v[186:187], v[186:187], v[164:165]
    v_cvt_pk_bf16_f32 v192, v186, v184
    v_cvt_pk_bf16_f32 v193, v182, v180
    v_cvt_pk_bf16_f32 v194, v178, v176
    v_cvt_pk_bf16_f32 v195, v174, v172
    v_cvt_pk_bf16_f32 v196, v187, v185
    v_cvt_pk_bf16_f32 v197, v183, v181
    v_cvt_pk_bf16_f32 v198, v179, v177
    v_cvt_pk_bf16_f32 v199, v175, v173
    v_perm_b32 v128, v65, v67, s80
    v_perm_b32 v129, v65, v67, s81
    v_perm_b32 v130, v67, v69, s80
    v_perm_b32 v131, v67, v69, s81
    v_perm_b32 v132, v69, v71, s80
    v_perm_b32 v133, v69, v71, s81
    v_perm_b32 v134, v71, v73, s80
    v_perm_b32 v135, v71, v73, s81
    v_perm_b32 v136, v73, v75, s80
    v_perm_b32 v137, v73, v75, s81
    buffer_store_dwordx4 v[192:195], v15, s[16:19], s48 offen sc1
    s_add_u32 s48, s48, 4224
    v_perm_b32 v138, v75, v77, s80
    v_perm_b32 v139, v75, v77, s81
    v_perm_b32 v140, v77, v79, s80
    v_perm_b32 v141, v77, v79, s81
    v_perm_b32 v142, v79, v81, s80
    v_perm_b32 v143, v79, v81, s81
    v_perm_b32 v144, v81, v83, s80
    v_perm_b32 v145, v81, v83, s81
    v_perm_b32 v146, v83, v85, s80
    buffer_store_dwordx4 v[196:199], v15, s[16:19], s48 offen sc1
    s_add_u32 s48, s48, 4224
    v_perm_b32 v147, v83, v85, s81
    v_lshlrev_b32 v150, 16, v87
    v_and_b32 v151, s83, v87
    v_lshlrev_b32 v152, 16, v89
    v_and_b32 v153, s83, v89
    v_lshlrev_b32 v154, 16, v91
    v_and_b32 v155, s83, v91
    v_lshlrev_b32 v156, 16, v93
    v_and_b32 v157, s83, v93
    v_lshlrev_b32 v158, 16, v95
    buffer_load_dwordx4 v49, s[20:23], s0 offen offset:1024 lds
    v_and_b32 v159, s83, v95
    v_lshlrev_b32 v160, 16, v97
    v_and_b32 v161, s83, v97
    v_lshlrev_b32 v162, 16, v99
    v_and_b32 v163, s83, v99
    v_lshlrev_b32 v164, 16, v101
    v_and_b32 v165, s83, v101
    v_pk_mov_b32 v[32:33], v[20:21], v[20:21] op_sel:[0,1]
    v_pk_mov_b32 v[34:35], v[22:23], v[22:23] op_sel:[0,1]
    s_waitcnt vmcnt(11)
    s_barrier
    ds_read_b128 v[16:19], v14 offset:0
    ds_read_b128 v[20:23], v14 offset:16
    ds_read_b64 v[64:65], v13 offset:640
    ds_read_b64 v[66:67], v13 offset:768
    ds_read_b64 v[68:69], v13 offset:896
    ds_read_b64 v[70:71], v13 offset:1056
    ds_read_b64 v[72:73], v13 offset:1184
    ds_read_b64 v[74:75], v13 offset:1312
    ds_read_b64 v[76:77], v13 offset:1440
    ds_read_b64 v[78:79], v13 offset:1568
    ds_read_b64 v[80:81], v13 offset:1696
    ds_read_b64 v[82:83], v13 offset:1824
    ds_read_b64 v[84:85], v13 offset:1952
    ds_read_b64 v[86:87], v13 offset:10560
    ds_read_b64 v[88:89], v13 offset:10688
    ds_read_b64 v[90:91], v13 offset:10816
    ds_read_b64 v[92:93], v13 offset:10944
    ds_read_b64 v[94:95], v13 offset:11072
    ds_read_b64 v[96:97], v13 offset:11200
    ds_read_b64 v[98:99], v13 offset:11328
    ds_read_b64 v[100:101], v13 offset:11456
    v_add_u32 v13, 38016, v13
    v_add_u32 v14, 1024, v14
    v_dot2_f32_bf16 v172, v128, v33, 0
    v_dot2_f32_bf16 v173, v129, v35, 0
    v_dot2_f32_bf16 v174, v130, v33, 0
    v_dot2_f32_bf16 v175, v131, v35, 0
    v_dot2_f32_bf16 v176, v132, v33, 0
    v_dot2_f32_bf16 v177, v133, v35, 0
    v_dot2_f32_bf16 v178, v134, v33, 0
    v_dot2_f32_bf16 v179, v135, v35, 0
    v_dot2_f32_bf16 v180, v136, v33, 0
    v_dot2_f32_bf16 v181, v137, v35, 0
    v_dot2_f32_bf16 v182, v138, v33, 0
    v_dot2_f32_bf16 v183, v139, v35, 0
    v_dot2_f32_bf16 v184, v140, v33, 0
    v_dot2_f32_bf16 v185, v141, v35, 0
    v_dot2_f32_bf16 v186, v142, v33, 0
    v_dot2_f32_bf16 v187, v143, v35, 0
    buffer_load_dwordx4 v50, s[20:23], s0 offen offset:2048 lds
    v_dot2_f32_bf16 v172, v132, v32, v172
    v_dot2_f32_bf16 v173, v133, v34, v173
    v_dot2_f32_bf16 v174, v134, v32, v174
    v_dot2_f32_bf16 v175, v135, v34, v175
    v_dot2_f32_bf16 v176, v136, v32, v176
    v_dot2_f32_bf16 v177, v137, v34, v177
    v_dot2_f32_bf16 v178, v138, v32, v178
    v_dot2_f32_bf16 v179, v139, v34, v179
    v_dot2_f32_bf16 v180, v140, v32, v180
    v_dot2_f32_bf16 v181, v141, v34, v181
    v_dot2_f32_bf16 v182, v142, v32, v182
    v_dot2_f32_bf16 v183, v143, v34, v183
    v_dot2_f32_bf16 v184, v144, v32, v184
    v_dot2_f32_bf16 v185, v145, v34, v185
    v_dot2_f32_bf16 v186, v146, v32, v186
    v_dot2_f32_bf16 v187, v147, v34, v187
    buffer_load_dwordx4 v51, s[20:23], s0 offen offset:3072 lds
    v_pk_mul_f32 v[172:173], v[172:173], v[150:151]
    v_pk_mul_f32 v[174:175], v[174:175], v[152:153]
    v_pk_mul_f32 v[176:177], v[176:177], v[154:155]
    v_pk_mul_f32 v[178:179], v[178:179], v[156:157]
    v_pk_mul_f32 v[180:181], v[180:181], v[158:159]
    v_pk_mul_f32 v[182:183], v[182:183], v[160:161]
    v_pk_mul_f32 v[184:185], v[184:185], v[162:163]
    v_pk_mul_f32 v[186:187], v[186:187], v[164:165]
    v_cvt_pk_bf16_f32 v200, v186, v184
    v_cvt_pk_bf16_f32 v201, v182, v180
    v_cvt_pk_bf16_f32 v202, v178, v176
    v_cvt_pk_bf16_f32 v203, v174, v172
    v_cvt_pk_bf16_f32 v204, v187, v185
    v_cvt_pk_bf16_f32 v205, v183, v181
    v_cvt_pk_bf16_f32 v206, v179, v177
    v_cvt_pk_bf16_f32 v207, v175, v173
    s_waitcnt lgkmcnt(0)
    v_perm_b32 v128, v64, v66, s80
    v_perm_b32 v129, v64, v66, s81
    v_perm_b32 v130, v66, v68, s80
    v_perm_b32 v131, v66, v68, s81
    v_perm_b32 v132, v68, v70, s80
    v_perm_b32 v133, v68, v70, s81
    v_perm_b32 v134, v70, v72, s80
    v_perm_b32 v135, v70, v72, s81
    v_perm_b32 v136, v72, v74, s80
    v_perm_b32 v137, v72, v74, s81
    v_perm_b32 v138, v74, v76, s80
    v_perm_b32 v139, v74, v76, s81
    v_perm_b32 v140, v76, v78, s80
    v_perm_b32 v141, v76, v78, s81
    v_perm_b32 v142, v78, v80, s80
    v_perm_b32 v143, v78, v80, s81
    v_perm_b32 v144, v80, v82, s80
    v_perm_b32 v145, v80, v82, s81
    v_perm_b32 v146, v82, v84, s80
    v_perm_b32 v147, v82, v84, s81
    v_lshlrev_b32 v150, 16, v86
    v_and_b32 v151, s83, v86
    v_lshlrev_b32 v152, 16, v88
    v_and_b32 v153, s83, v88
    v_lshlrev_b32 v154, 16, v90
    v_and_b32 v155, s83, v90
    v_lshlrev_b32 v156, 16, v92
    v_and_b32 v157, s83, v92
    buffer_store_dwordx4 v[200:203], v15, s[16:19], s48 offen sc1
    s_add_u32 s48, s48, 4224
    v_lshlrev_b32 v158, 16, v94
    v_and_b32 v159, s83, v94
    v_lshlrev_b32 v160, 16, v96
    v_and_b32 v161, s83, v96
    v_lshlrev_b32 v162, 16, v98
    v_and_b32 v163, s83, v98
    v_lshlrev_b32 v164, 16, v100
    v_and_b32 v165, s83, v100
    v_dot2_f32_bf16 v172, v128, v17, 0
    v_dot2_f32_bf16 v173, v129, v19, 0
    v_dot2_f32_bf16 v174, v130, v17, 0
    v_dot2_f32_bf16 v175, v131, v19, 0
    v_dot2_f32_bf16 v176, v132, v17, 0
    v_dot2_f32_bf16 v177, v133, v19, 0
    v_dot2_f32_bf16 v178, v134, v17, 0
    v_dot2_f32_bf16 v179, v135, v19, 0
    v_dot2_f32_bf16 v180, v136, v17, 0
    v_dot2_f32_bf16 v181, v137, v19, 0
    v_dot2_f32_bf16 v182, v138, v17, 0
    v_dot2_f32_bf16 v183, v139, v19, 0
    v_dot2_f32_bf16 v184, v140, v17, 0
    v_dot2_f32_bf16 v185, v141, v19, 0
    v_dot2_f32_bf16 v186, v142, v17, 0
    v_dot2_f32_bf16 v187, v143, v19, 0
    v_dot2_f32_bf16 v172, v132, v16, v172
    v_dot2_f32_bf16 v173, v133, v18, v173
    v_dot2_f32_bf16 v174, v134, v16, v174
    v_dot2_f32_bf16 v175, v135, v18, v175
    buffer_store_dwordx4 v[204:207], v15, s[16:19], s48 offen sc1
    s_add_u32 s48, s48, 528000
    v_dot2_f32_bf16 v176, v136, v16, v176
    v_dot2_f32_bf16 v177, v137, v18, v177
    v_dot2_f32_bf16 v178, v138, v16, v178
    v_dot2_f32_bf16 v179, v139, v18, v179
    v_dot2_f32_bf16 v180, v140, v16, v180
    v_dot2_f32_bf16 v181, v141, v18, v181
    v_dot2_f32_bf16 v182, v142, v16, v182
    v_dot2_f32_bf16 v183, v143, v18, v183
    v_dot2_f32_bf16 v184, v144, v16, v184
    v_dot2_f32_bf16 v185, v145, v18, v185
    v_dot2_f32_bf16 v186, v146, v16, v186
    v_dot2_f32_bf16 v187, v147, v18, v187
    v_pk_mul_f32 v[172:173], v[172:173], v[150:151]
    v_pk_mul_f32 v[174:175], v[174:175], v[152:153]
    v_pk_mul_f32 v[176:177], v[176:177], v[154:155]
    v_pk_mul_f32 v[178:179], v[178:179], v[156:157]
    v_pk_mul_f32 v[180:181], v[180:181], v[158:159]
    v_pk_mul_f32 v[182:183], v[182:183], v[160:161]
    v_pk_mul_f32 v[184:185], v[184:185], v[162:163]
    v_pk_mul_f32 v[186:187], v[186:187], v[164:165]
    v_cvt_pk_bf16_f32 v192, v186, v184
    v_cvt_pk_bf16_f32 v193, v182, v180
    v_cvt_pk_bf16_f32 v194, v178, v176
    v_cvt_pk_bf16_f32 v195, v174, v172
    v_cvt_pk_bf16_f32 v196, v187, v185
    v_cvt_pk_bf16_f32 v197, v183, v181
    v_cvt_pk_bf16_f32 v198, v179, v177
    v_cvt_pk_bf16_f32 v199, v175, v173
    v_perm_b32 v128, v65, v67, s80
    v_perm_b32 v129, v65, v67, s81
    v_perm_b32 v130, v67, v69, s80
    v_perm_b32 v131, v67, v69, s81
    v_perm_b32 v132, v69, v71, s80
    v_perm_b32 v133, v69, v71, s81
    v_perm_b32 v134, v71, v73, s80
    v_perm_b32 v135, v71, v73, s81
    v_perm_b32 v136, v73, v75, s80
    v_perm_b32 v137, v73, v75, s81
    v_perm_b32 v138, v75, v77, s80
    v_perm_b32 v139, v75, v77, s81
    v_perm_b32 v140, v77, v79, s80
    buffer_store_dwordx4 v[192:195], v15, s[16:19], s48 offen sc1
    s_add_u32 s48, s48, 4224
    v_perm_b32 v141, v77, v79, s81
    v_perm_b32 v142, v79, v81, s80
    v_perm_b32 v143, v79, v81, s81
    v_perm_b32 v144, v81, v83, s80
    v_perm_b32 v145, v81, v83, s81
    v_perm_b32 v146, v83, v85, s80
    v_perm_b32 v147, v83, v85, s81
    v_lshlrev_b32 v150, 16, v87
    v_and_b32 v151, s83, v87
    v_lshlrev_b32 v152, 16, v89
    v_and_b32 v153, s83, v89
    v_lshlrev_b32 v154, 16, v91
    v_and_b32 v155, s83, v91
    buffer_store_dwordx4 v[196:199], v15, s[16:19], s48 offen sc1
    s_add_u32 s48, s48, 4224
    v_lshlrev_b32 v156, 16, v93
    v_and_b32 v157, s83, v93
    v_lshlrev_b32 v158, 16, v95
    v_and_b32 v159, s83, v95
    v_lshlrev_b32 v160, 16, v97
    v_and_b32 v161, s83, v97
    v_lshlrev_b32 v162, 16, v99
    v_and_b32 v163, s83, v99
    v_lshlrev_b32 v164, 16, v101
    v_and_b32 v165, s83, v101
    v_pk_mov_b32 v[32:33], v[20:21], v[20:21] op_sel:[0,1]
    v_pk_mov_b32 v[34:35], v[22:23], v[22:23] op_sel:[0,1]
    v_dot2_f32_bf16 v172, v128, v33, 0
    v_dot2_f32_bf16 v173, v129, v35, 0
    v_dot2_f32_bf16 v174, v130, v33, 0
    v_dot2_f32_bf16 v175, v131, v35, 0
    v_dot2_f32_bf16 v176, v132, v33, 0
    v_dot2_f32_bf16 v177, v133, v35, 0
    v_dot2_f32_bf16 v178, v134, v33, 0
    v_dot2_f32_bf16 v179, v135, v35, 0
    v_dot2_f32_bf16 v180, v136, v33, 0
    v_dot2_f32_bf16 v181, v137, v35, 0
    v_dot2_f32_bf16 v182, v138, v33, 0
    v_dot2_f32_bf16 v183, v139, v35, 0
    v_dot2_f32_bf16 v184, v140, v33, 0
    v_dot2_f32_bf16 v185, v141, v35, 0
    v_dot2_f32_bf16 v186, v142, v33, 0
    v_dot2_f32_bf16 v187, v143, v35, 0
    v_dot2_f32_bf16 v172, v132, v32, v172
    v_dot2_f32_bf16 v173, v133, v34, v173
    v_dot2_f32_bf16 v174, v134, v32, v174
    v_dot2_f32_bf16 v175, v135, v34, v175
    v_dot2_f32_bf16 v176, v136, v32, v176
    v_dot2_f32_bf16 v177, v137, v34, v177
    v_dot2_f32_bf16 v178, v138, v32, v178
    v_dot2_f32_bf16 v179, v139, v34, v179
    v_dot2_f32_bf16 v180, v140, v32, v180
    v_dot2_f32_bf16 v181, v141, v34, v181
    v_dot2_f32_bf16 v182, v142, v32, v182
    v_dot2_f32_bf16 v183, v143, v34, v183
    v_dot2_f32_bf16 v184, v144, v32, v184
    v_dot2_f32_bf16 v185, v145, v34, v185
    v_dot2_f32_bf16 v186, v146, v32, v186
    v_dot2_f32_bf16 v187, v147, v34, v187
    v_pk_mul_f32 v[172:173], v[172:173], v[150:151]
    v_pk_mul_f32 v[174:175], v[174:175], v[152:153]
    v_pk_mul_f32 v[176:177], v[176:177], v[154:155]
    v_pk_mul_f32 v[178:179], v[178:179], v[156:157]
    v_pk_mul_f32 v[180:181], v[180:181], v[158:159]
    v_pk_mul_f32 v[182:183], v[182:183], v[160:161]
    v_pk_mul_f32 v[184:185], v[184:185], v[162:163]
    v_pk_mul_f32 v[186:187], v[186:187], v[164:165]
    v_cvt_pk_bf16_f32 v200, v186, v184
    v_cvt_pk_bf16_f32 v201, v182, v180
    v_cvt_pk_bf16_f32 v202, v178, v176
    v_cvt_pk_bf16_f32 v203, v174, v172
    v_cvt_pk_bf16_f32 v204, v187, v185
    v_cvt_pk_bf16_f32 v205, v183, v181
    v_cvt_pk_bf16_f32 v206, v179, v177
    v_cvt_pk_bf16_f32 v207, v175, v173
    buffer_store_dwordx4 v[200:203], v15, s[16:19], s48 offen sc1
    s_add_u32 s48, s48, 4224
    buffer_store_dwordx4 v[204:207], v15, s[16:19], s48 offen sc1
    s_add_u32 s48, s48, 528000
    v_lshrrev_b32 v4, 5, v1
    v_and_b32 v5, 31, v1
    s_lshr_b32 s4, s92, 1
    s_and_b32 s77, s92, 1
    s_lshl_b32 s5, s90, 5
    s_add_u32 s5, s5, s91
    s_lshl_b32 s5, s5, 1
    s_add_u32 s5, s5, s4
    s_lshl_b32 s6, s77, 9
    s_add_u32 s6, s6, s5
    s_lshr_b32 s6, s6, 4
    s_lshl_b32 s6, s6, 7
    s_add_u32 s57, s6, 16384000
    s_lshl_b32 s66, s5, 12
    s_lshl_b32 s6, s77, 11
    s_mul_i32 s67, s5, 4224
    s_add_u32 s65, s67, 8388608
    s_add_u32 s67, s67, s6
    s_add_u32 s67, s67, 13631488
    s_lshl_b32 s5, s5, 1
    v_mov_b32 v63, s5
    s_add_u32 m0, s61, 49152
    s_nop 0
    buffer_load_dwordx4 v48, s[20:23], s50 offen offset:0 lds
    v_mov_b32 v36, s66
    s_add_u32 s66, s66, s6
    s_add_u32 s89, s66, 2
    s_mul_i32 s7, s4, 4352
    s_add_u32 s7, s7, 147472
    s_mul_i32 s4, s4, 22784
    s_add_u32 s4, s4, 98320
    s_mul_i32 s5, s77, 9288
    s_sub_u32 s63, s4, s5
    s_add_u32 s64, s4, s6
    s_add_u32 s64, s64, 18672
    s_add_u32 s41, s7, s6
    s_add_u32 s41, s41, 116
    v_lshl_add_u32 v56, v1, 2, s63
    s_sub_u32 s93, s7, s4
    s_sub_u32 s93, s93, 18560
    s_add_u32 s5, s77, 27
    v_min_u32 v57, s5, v1
    s_mul_i32 s5, s77, s93
    s_add_u32 s5, s5, s4
    s_add_u32 s5, s5, 18560
    buffer_load_dwordx4 v49, s[20:23], s50 offen offset:1024 lds
    v_lshl_add_u32 v57, v57, 2, s5
    s_sub_u32 s5, s4, s6
    s_add_u32 s5, s5, 16464
    v_and_b32 v60, -16, v61
    v_sub_u32 v60, s5, v60
    s_lshl_b32 s5, s77, 8
    s_add_u32 s4, s4, s5
    s_add_u32 s7, s7, s5
    v_lshrrev_b32 v98, 4, v1
    v_and_b32 v125, 3, v1
    v_bfe_u32 v99, v1, 2, 2
    v_mul_u32_u24 v54, 4640, v125
    v_lshlrev_b32 v100, 7, v99
    v_sub_u32 v54, v54, v100
    v_lshl_add_u32 v54, v98, 4, v54
L_pad7:
    s_cbranch_execz L_return
    s_add_u32 s5, s4, 384
    v_add_u32 v54, s5, v54
    v_and_b32 v126, 1, v1
    v_mul_u32_u24 v55, s93, v126
    v_sub_u32 v55, s7, v55
    v_bfe_u32 v101, v1, 1, 3
    buffer_load_dwordx4 v50, s[20:23], s50 offen offset:2048 lds
    v_add_u32 v101, v101, v98
    v_lshl_add_u32 v55, v101, 4, v55
    v_mul_u32_u24 v37, 0x202, v126
    v_sub_u32 v37, 0x302, v37
    v_lshlrev_b32 v37, 16, v37
    v_or_b32 v37, 0xc0c, v37
    v_lshlrev_b32 v126, 7, v4
    s_mul_i32 s61, s92, 12288
    s_add_u32 s5, s61, 57344
    v_add_u32 v58, s5, v2
    s_xor_b32 s5, s92, 1
    s_mul_i32 s5, s5, 12288
    s_add_u32 s5, s5, 57344
    v_add_u32 v59, s5, v2
    v_lshlrev_b32 v102, 1, v98
    v_xor_b32 v102, v7, v102
    v_lshlrev_b32 v102, 4, v102
    s_mul_i32 s6, s92, 458752
    s_lshl_b32 s5, s87, 7
    s_add_u32 s6, s6, s5
    s_bfe_u32 s6, s86, 0x10001
    buffer_load_dwordx4 v51, s[20:23], s50 offen offset:3072 lds
    s_mul_i32 s6, s6, 3
    s_xor_b32 s7, s87, 3
    s_min_u32 s7, s7, 1
    s_sub_u32 s7, 1, s7
    s_mul_i32 s6, s6, s7
    s_xor_b32 s93, s86, s87
    s_and_b32 s93, s93, 1
    s_mul_i32 s93, s93, 7
    s_add_u32 s6, s6, s93
    s_min_u32 s7, s90, 6
    s_add_u32 s93, s6, s7
    s_sub_u32 s7, s93, 14
    s_min_u32 s93, s93, s7
    s_lshl_b32 s93, s93, 15
    s_mov_b32 s62, s93
    v_lshl_add_u32 v52, v98, 9, v100
    v_lshl_add_u32 v52, v125, 3, v52
    v_and_b32 v102, 3, v6
    v_lshl_add_u32 v52, v102, 5, v52
    v_add_u32 v52, s61, v52
    v_xor_b32 v53, 32, v52
    s_waitcnt vmcnt(4)
    s_mov_b32 s79, 1
    s_atomic_add s79, s[16:17], s56
    s_load_dword s82, s[32:33], 0
    s_load_dword s83, s[32:33], 128
    v_xor_b32 v62, 64, v52
    v_xor_b32 v123, 96, v52
    s_lshl_b32 s88, s92, 12
    s_add_u32 s88, s88, 147456
    v_lshlrev_b32 v125, 7, v6
    s_sub_u32 s6, s88, s61
    v_add_u32 v43, s6, v52
    v_add_u32 v44, s6, v53
    v_add_u32 v45, s6, v62
    v_add_u32 v46, s6, v123
    s_add_u32 s6, s93, 32768
    s_sub_u32 s7, s6, 458752
    s_min_u32 s0, s6, s7
    s_add_u32 s6, s93, 65536
    s_sub_u32 s7, s6, 458752
    s_min_u32 s1, s6, s7
    s_add_u32 s6, s93, 98304
    s_sub_u32 s7, s6, 458752
    s_min_u32 s3, s6, s7
    s_add_u32 s6, s93, 131072
    s_sub_u32 s7, s6, 458752
    s_min_u32 s39, s6, s7
    s_add_u32 s6, s93, 163840
    s_add_u32 m0, s61, 53248
    s_nop 0
    buffer_load_dwordx4 v48, s[20:23], s51 offen offset:0 lds
    s_sub_u32 s7, s6, 458752
    s_min_u32 s40, s6, s7
    s_add_u32 s6, s93, 196608
    s_sub_u32 s7, s6, 458752
    s_min_u32 s50, s6, s7
    s_add_u32 s6, s93, 229376
    s_sub_u32 s7, s6, 458752
    s_min_u32 s51, s6, s7
    s_add_u32 s6, s93, 262144
    s_sub_u32 s7, s6, 458752
    s_min_u32 s52, s6, s7
    s_add_u32 s6, s93, 294912
    s_sub_u32 s7, s6, 458752
    s_min_u32 s53, s6, s7
    s_add_u32 s6, s93, 327680
    s_sub_u32 s7, s6, 458752
    s_min_u32 s54, s6, s7
    s_add_u32 s6, s93, 360448
    s_sub_u32 s7, s6, 458752
    s_min_u32 s55, s6, s7
    s_add_u32 s6, s93, 393216
    s_sub_u32 s7, s6, 458752
    buffer_load_dwordx4 v49, s[20:23], s51 offen offset:1024 lds
    s_min_u32 s80, s6, s7
    s_add_u32 s6, s93, 425984
    s_sub_u32 s7, s6, 458752
    s_min_u32 s81, s6, s7
    s_lshl_b32 s5, s87, 7
    s_and_b32 s6, s87, 0
    s_lshl_b32 s7, s86, 1
    s_add_u32 s7, s7, s6
    s_lshl_b32 s70, s7, 15
    s_add_u32 s70, s70, s5
    s_xor_b32 s71, s70, 0x8000
    s_lshl_b32 s72, s7, 9
    s_add_u32 s72, s72, 15990784
    s_xor_b32 s73, s72, 0x200
    s_mul_i32 s4, s92, 14336
    s_mul_i32 s74, s7, 114688
    s_add_u32 s74, s74, s4
    s_add_u32 s75, s74, 57344
    s_lshl_b32 s4, s92, 3
    v_add_u32 v102, s4, v6
    v_add_lshl_u32 v114, s4, v102, 3
    v_lshlrev_b32 v103, 4, v7
    v_lshl_add_u32 v113, v102, 10, v103
    buffer_load_dwordx4 v50, s[20:23], s51 offen offset:2048 lds
    v_mul_u32_u24 v112, 4224, v6
    v_add_u32 v112, v112, v103
    s_lshl_b32 s4, s87, 2
    s_add_u32 s4, s4, s92
    s_mul_i32 s68, s4, 67584
    s_lshl_b32 s7, s86, 7
    s_add_u32 s68, s68, s7
    s_add_u32 s68, s68, 13631488
    s_lshl_b32 s58, s92, 7
    s_lshl_b32 s7, s7, 2
    s_add_u32 s58, s58, s7
    s_add_u32 s58, s58, 16252928
    s_lshl_b32 s4, s4, 7
    s_lshr_b32 s7, s86, 4
    s_lshl_b32 s7, s7, 12
    s_add_u32 s4, s4, s7
    s_add_u32 s59, s4, 16384000
    s_mul_i32 s69, s92, 2080
    s_add_u32 s69, s69, 147456
    v_mul_u32_u24 v103, 1040, v7
    v_and_b32 v101, 6, v6
    v_add_u32 v103, v103, v101
    buffer_load_dwordx4 v51, s[20:23], s51 offen offset:3072 lds
    v_and_b32 v101, 1, v6
    v_lshl_add_u32 v103, v101, 3, v103
    s_lshl_b32 s4, s92, 4
    v_add_u32 v103, s4, v103
    s_lshl_b32 s6, s6, 6
    s_add_u32 s4, s6, 147456
    v_add_u32 v115, s4, v103
    s_sub_u32 s4, 147520, s6
    v_add_u32 v116, s4, v103
    v_lshrrev_b32 v103, 4, v1
    v_xor_b32 v103, v103, v7
    v_lshlrev_b32 v103, 4, v103
    v_and_b32 v101, 15, v1
    v_lshl_add_u32 v103, v101, 8, v103
    v_add_u32 v117, s61, v103
    v_xor_b32 v118, 64, v117
    v_lshlrev_b32 v103, 1, v7
    v_xor_b32 v103, v103, v6
    v_lshlrev_b32 v103, 4, v103
    v_lshl_add_u32 v121, v102, 8, v103
    v_add_u32 v121, 0, v121
    v_xor_b32 v122, 16, v121
    s_barrier
    global_load_ushort v63, v63, s[98:99]
    buffer_load_ushort v36, v36, s[24:27], 0 offen
    s_add_u32 m0, s64, 0
    s_nop 0
    buffer_load_dwordx4 v2, s[24:27], s66 offen offset:0  lds
    buffer_load_dwordx4 v2, s[24:27], s66 offen offset:1024  lds
    s_add_u32 m0, s41, 0
    s_nop 0
    buffer_load_dwordx4 v2, s[24:27], s89 offen offset:0  lds
    buffer_load_dwordx4 v2, s[24:27], s89 offen offset:1024  lds
    s_add_u32 m0, s61, 8192
    s_nop 0
    buffer_load_dwordx4 v48, s[20:23], s1 offen offset:0 lds
    buffer_load_dwordx4 v49, s[20:23], s1 offen offset:1024 lds
    buffer_load_dwordx4 v50, s[20:23], s1 offen offset:2048 lds
    buffer_load_dwordx4 v51, s[20:23], s1 offen offset:3072 lds
    s_lshr_b32 s1, s1, 5
    s_mov_b64 exec, 0
    s_cmp_lg_u32 s92, 0
    s_cbranch_scc1 L_w_34
    s_call_b64 s[6:7], L_pad4
    s_branch L_visited_33
L_w_34:
    s_cmp_lg_u32 s92, 1
    s_cbranch_scc1 L_w_35
    s_call_b64 s[6:7], L_return
    s_branch L_visited_33
L_w_35:
    s_cmp_lg_u32 s92, 2
    s_cbranch_scc1 L_w_36
    s_call_b64 s[6:7], L_return
    s_branch L_visited_33
L_w_36:
    s_call_b64 s[6:7], L_return
L_visited_33:
    s_mov_b64 exec, -1
    s_lshr_b32 s62, s62, 5
    s_lshr_b32 s0, s0, 5
    s_lshr_b32 s50, s50, 5
    s_lshr_b32 s51, s51, 5
    s_waitcnt vmcnt(30)
    ds_read_b64_tr_b16 a[0:1], v52 offset:0
    ds_read_b64_tr_b16 a[2:3], v52 offset:2048
    ds_read_b64_tr_b16 a[4:5], v53 offset:0
    ds_read_b64_tr_b16 a[6:7], v53 offset:2048
    ds_read_b64_tr_b16 a[8:9], v62 offset:0
    ds_read_b64_tr_b16 a[10:11], v62 offset:2048
    ds_read_b64_tr_b16 a[12:13], v123 offset:0
    ds_read_b64_tr_b16 a[14:15], v123 offset:2048
    s_waitcnt vmcnt(24)
    ds_read_b64_tr_b16 a[16:17], v52 offset:4096
    ds_read_b64_tr_b16 a[18:19], v52 offset:6144
    ds_read_b64_tr_b16 a[20:21], v53 offset:4096
    ds_read_b64_tr_b16 a[22:23], v53 offset:6144
    ds_read_b64_tr_b16 a[24:25], v62 offset:4096
    ds_read_b64_tr_b16 a[26:27], v62 offset:6144
    ds_read_b64_tr_b16 a[28:29], v123 offset:4096
    ds_read_b64_tr_b16 a[30:31], v123 offset:6144
    s_waitcnt vmcnt(0)
    ds_read_b64_tr_b16 a[32:33], v52 offset:8192
    ds_read_b64_tr_b16 a[34:35], v52 offset:10240
    ds_read_b64_tr_b16 a[36:37], v53 offset:8192
    ds_read_b64_tr_b16 a[38:39], v53 offset:10240
    ds_read_b64_tr_b16 a[40:41], v62 offset:8192
    ds_read_b64_tr_b16 a[42:43], v62 offset:10240
    ds_read_b64_tr_b16 a[44:45], v123 offset:8192
    ds_read_b64_tr_b16 a[46:47], v123 offset:10240
    s_waitcnt lgkmcnt(0)
    s_min_u32 s82, s82, s83
    s_cmp_ge_u32 s82, 128
    s_cbranch_scc0 L_slow_38
L_back_39:
    s_load_dword s44, s[16:17], s60 offset:0
    s_load_dword s45, s[16:17], s60 offset:128
    s_load_dword s46, s[16:17], s60 offset:256
    s_load_dword s47, s[16:17], s60 offset:384
    s_load_dword s42, s[16:17], s60 offset:512
    s_load_dword s43, s[16:17], s60 offset:640
    s_load_dword s98, s[16:17], s60 offset:768
    s_load_dword s99, s[16:17], s60 offset:896
    s_add_u32 m0, s61, 0
    s_nop 0
    buffer_load_dwordx4 v48, s[20:23], s3 offen offset:0 lds
    buffer_load_dwordx4 v49, s[20:23], s3 offen offset:1024 lds
    buffer_load_dwordx4 v50, s[20:23], s3 offen offset:2048 lds
    buffer_load_dwordx4 v51, s[20:23], s3 offen offset:3072 lds
    s_lshr_b32 s3, s3, 5
    s_add_u32 m0, s61, 4096
    s_nop 0
    buffer_load_dwordx4 v48, s[20:23], s39 offen offset:0 lds
    buffer_load_dwordx4 v49, s[20:23], s39 offen offset:1024 lds
    buffer_load_dwordx4 v50, s[20:23], s39 offen offset:2048 lds
    buffer_load_dwordx4 v51, s[20:23], s39 offen offset:3072 lds
    s_lshr_b32 s39, s39, 5
    s_add_u32 m0, s61, 8192
    s_nop 0
    buffer_load_dwordx4 v48, s[20:23], s40 offen offset:0 lds
    buffer_load_dwordx4 v49, s[20:23], s40 offen offset:1024 lds
    buffer_load_dwordx4 v50, s[20:23], s40 offen offset:2048 lds
    buffer_load_dwordx4 v51, s[20:23], s40 offen offset:3072 lds
    s_lshr_b32 s40, s40, 5
    s_waitcnt lgkmcnt(0)
    s_min_u32 s44, s44, s45
    s_min_u32 s44, s44, s46
    s_min_u32 s44, s44, s47
    s_min_u32 s44, s44, s42
    s_min_u32 s44, s44, s43
    s_min_u32 s44, s44, s98
    s_min_u32 s44, s44, s99
    s_cmp_ge_u32 s44, 1
    s_cbranch_scc0 L_slow_40
L_back_41:
    s_barrier
    s_add_u32 m0, s63, 13920
    s_nop 0
    buffer_load_dwordx4 v2, s[16:19], s65 offen offset:0 sc1 lds
    buffer_load_dwordx4 v2, s[16:19], s65 offen offset:1024 sc1 lds
    buffer_load_dwordx4 v2, s[16:19], s65 offen offset:2048 sc1 lds
    buffer_load_dwordx4 v2, s[16:19], s65 offen offset:3072 sc1 lds
    s_add_u32 m0, s63, 9276
    s_nop 0
    buffer_load_dwordx4 v2, s[16:19], s65 offen offset:0 sc1 lds
    buffer_load_dwordx4 v2, s[16:19], s65 offen offset:1024 sc1 lds
    buffer_load_dwordx4 v2, s[16:19], s65 offen offset:2048 sc1 lds
    buffer_load_dwordx4 v2, s[16:19], s65 offen offset:3072 sc1 lds
    buffer_load_dwordx4 v[40:43], v113, s[8:11], s70 offen
    buffer_load_dwordx4 v[44:47], v113, s[8:11], s71 offen
    buffer_load_dwordx2 v[124:125], v114, s[16:19], s72 offen sc1
    buffer_load_dwordx2 v[126:127], v114, s[16:19], s73 offen sc1
    v_add_u32 v4, 18016, v56
    v_add_u32 v5, 13372, v56
    v_mul_u32_u24 v36, s77, v36
    v_add_u32 v0, 4, v1
    v_min_u32 v0, 32, v0
    v_lshrrev_b32 v0, 5, v0
    v_mul_u32_u24 v36, v0, v36
    v_lshlrev_b32 v36, 16, v36
    v_mov_b32 v12, 0
    ds_write2st64_b32 v4, v12, v12 offset0:0 offset1:1
    ds_write2st64_b32 v5, v12, v12 offset0:0 offset1:1
    ds_write_b32 v57, v36
    s_waitcnt vmcnt(20)
    ds_read_b64_tr_b16 a[48:49], v52 offset:0
    ds_read_b64_tr_b16 a[50:51], v52 offset:2048
    ds_read_b64_tr_b16 a[52:53], v53 offset:0
    ds_read_b64_tr_b16 a[54:55], v53 offset:2048
    ds_read_b64_tr_b16 a[56:57], v62 offset:0
    ds_read_b64_tr_b16 a[58:59], v62 offset:2048
    ds_read_b64_tr_b16 a[60:61], v123 offset:0
    ds_read_b64_tr_b16 a[62:63], v123 offset:2048
    s_waitcnt vmcnt(16)
    ds_read_b64_tr_b16 a[64:65], v52 offset:4096
    ds_read_b64_tr_b16 a[66:67], v52 offset:6144
    ds_read_b64_tr_b16 a[68:69], v53 offset:4096
    ds_read_b64_tr_b16 a[70:71], v53 offset:6144
    ds_read_b64_tr_b16 a[72:73], v62 offset:4096
    ds_read_b64_tr_b16 a[74:75], v62 offset:6144
    ds_read_b64_tr_b16 a[76:77], v123 offset:4096
    ds_read_b64_tr_b16 a[78:79], v123 offset:6144
    s_waitcnt vmcnt(12)
    ds_read_b64_tr_b16 a[80:81], v52 offset:8192
    ds_read_b64_tr_b16 a[82:83], v52 offset:10240
    ds_read_b64_tr_b16 a[84:85], v53 offset:8192
    ds_read_b64_tr_b16 a[86:87], v53 offset:10240
    ds_read_b64_tr_b16 a[88:89], v62 offset:8192
    ds_read_b64_tr_b16 a[90:91], v62 offset:10240
    ds_read_b64_tr_b16 a[92:93], v123 offset:8192
    ds_read_b64_tr_b16 a[94:95], v123 offset:10240
    s_waitcnt lgkmcnt(0)
    s_waitcnt vmcnt(0) lgkmcnt(0)
    s_barrier
    ds_read_b128 v[160:163], v55 offset:0
    ds_read_b128 v[128:131], v54 offset:3584
    ds_read_b128 v[132:135], v54 offset:3072
    ds_read_b128 v[136:139], v54 offset:2560
    ds_read_b128 v[140:143], v54 offset:2048
    s_branch L_join
L_slow_14:
    s_mov_b32 s78, 0x10000
L_slow_14_l:
    buffer_load_dword v127, v126, s[32:35], 0 offen sc1
    s_sub_u32 s78, s78, 1
    s_cmp_eq_u32 s78, 0
    s_waitcnt vmcnt(0)
    s_cbranch_scc1 L_back_15
    v_cmp_gt_u32 vcc, 128, v127
    s_cbranch_vccnz L_slow_14_l
    s_branch L_back_15
L_slow_16:
    s_mov_b32 s78, 0x10000
L_slow_16_l:
    buffer_load_dword v127, v125, s[16:19], s60 offen sc1
    s_sub_u32 s78, s78, 1
    s_cmp_eq_u32 s78, 0
    s_waitcnt vmcnt(0)
    s_cbranch_scc1 L_back_17
    v_cmp_gt_u32 vcc, 1, v127
    s_cbranch_vccnz L_slow_16_l
    s_branch L_back_17
L_slow_18:
    s_mov_b32 s78, 0x10000
L_slow_18_l:
    s_mov_b32 s83, 0
    s_atomic_add s83, s[16:17], s58 glc
    s_sub_u32 s78, s78, 1
    s_cmp_eq_u32 s78, 0
    s_waitcnt lgkmcnt(0)
    s_cbranch_scc1 L_back_19
    s_and_b32 s83, s83, 255
    s_cmp_ge_u32 s83, 7
    s_cbranch_scc0 L_slow_18_l
    s_branch L_back_19
L_slow_22:
    s_mov_b32 s78, 0x10000
L_slow_22_l:
    s_mov_b32 s83, 0
    s_atomic_add s83, s[16:17], s58 glc
    s_sub_u32 s78, s78, 1
    s_cmp_eq_u32 s78, 0
    s_waitcnt lgkmcnt(0)
    s_cbranch_scc1 L_back_23
    s_cmp_ge_u32 s83, 1792
    s_cbranch_scc0 L_slow_22_l
    s_branch L_back_23
L_slow_24:
    s_mov_b32 s78, 0x10000
L_slow_24_l:
    s_mov_b32 s83, 0
    s_atomic_add s83, s[16:17], s59 glc
    s_sub_u32 s78, s78, 1
    s_cmp_eq_u32 s78, 0
    s_waitcnt lgkmcnt(0)
    s_cbranch_scc1 L_back_25
    s_cmp_ge_u32 s83, 16
    s_cbranch_scc0 L_slow_24_l
    s_branch L_back_25
L_slow_38:
    s_mov_b32 s78, 0x10000
L_slow_38_l:
    buffer_load_dword v127, v126, s[32:35], 0 offen sc1
    s_sub_u32 s78, s78, 1
    s_cmp_eq_u32 s78, 0
    s_waitcnt vmcnt(0)
    s_cbranch_scc1 L_back_39
    v_cmp_gt_u32 vcc, 128, v127
    s_cbranch_vccnz L_slow_38_l
    s_branch L_back_39
L_slow_40:
    s_mov_b32 s78, 0x10000
L_slow_40_l:
    buffer_load_dword v127, v125, s[16:19], s60 offen sc1
    s_sub_u32 s78, s78, 1
    s_cmp_eq_u32 s78, 0
    s_waitcnt vmcnt(0)
    s_cbranch_scc1 L_back_41
    v_cmp_gt_u32 vcc, 1, v127
    s_cbranch_vccnz L_slow_40_l
    s_branch L_back_41
L_end:
    s_endpgm
.section .rodata,"a"
.p2align 6
.amdhsa_kernel recurrent_scan__ssm_conv_h3__glu_gated_geglu__prompt_kernel
  .amdhsa_next_free_vgpr 512
  .amdhsa_next_free_sgpr 102
  .amdhsa_accum_offset 256
  .amdhsa_group_segment_fixed_size 0
  .amdhsa_kernarg_size 104
  .amdhsa_user_sgpr_count 2
  .amdhsa_user_sgpr_kernarg_segment_ptr 1
  .amdhsa_system_sgpr_workgroup_id_x 1
.end_amdhsa_kernel
```
